```python
import torch

def _softmax(x, axis=-1):
    return torch.softmax(x, dim=axis)
def _gelu(x):
    return torch.nn.functional.gelu(x, approximate="tanh")
def _silu(x):
    return torch.nn.functional.silu(x)
def _sigmoid(x):
    return torch.sigmoid(x)
def _layernorm(x, axis=-1, eps=1e-5):
    m = x.mean(dim=axis, keepdim=True)
    v = x.var(dim=axis, keepdim=True, unbiased=False)
    return (x - m) / torch.sqrt(v + eps)
def _scatter_add(tgt, idx, src, axis=0):
    return tgt.clone().index_add_(axis, idx, src)
def _segment_sum(src, seg, n):
    out = torch.zeros((n,) + src.shape[1:], dtype=src.dtype)
    return out.index_add_(0, seg, src)
def _pad(x, pw):
    flat = tuple(v for pair in reversed(pw) for v in pair)
    return torch.nn.functional.pad(x, flat)

kernel_name = 'parallel_sum__sliding_local_dilated__glu_gated_bilinear__prompt'

def setup_inputs():

    _w = (lambda a: (lambda t: t.to(torch.bfloat16) if t.is_floating_point() else t)(torch.as_tensor(a)))
    def _A_setup():
        B, S, D = 1, 2048, 448
        return {
            "x": _w((lambda *s: torch.randn(*s, dtype=torch.bfloat16) * 0.05)(B, S, D)),
            "wqkv": _w((lambda *s: torch.randn(*s, dtype=torch.bfloat16) * 0.05)(D, 3 * D)),
            "wo": _w((lambda *s: torch.randn(*s, dtype=torch.bfloat16) * 0.05)(D, D)),
        }
    _A_in = _A_setup()

    def _B_setup():
        B, S, D, F = 1, 2048, 448, 1792
        return {
            "x": _w((lambda *s: torch.randn(*s, dtype=torch.bfloat16) * 0.05)(B, S, D)),
            "w_gate": _w((lambda *s: torch.randn(*s, dtype=torch.bfloat16) * 0.8)(D, F) * (D ** -0.5)),
            "w_up": _w((lambda *s: torch.randn(*s, dtype=torch.bfloat16) * 0.8)(D, F) * (D ** -0.5)),
            "w_down": _w((lambda *s: torch.randn(*s, dtype=torch.bfloat16) * 0.8)(F, D) * (F ** -0.5)),
        }
    _B_in = _B_setup()

    return {
        "A_x": _A_in["x"],
        "A_wqkv": _A_in["wqkv"],
        "A_wo": _A_in["wo"],
        "B_x": _B_in["x"],
        "B_w_gate": _B_in["w_gate"],
        "B_w_up": _B_in["w_up"],
        "B_w_down": _B_in["w_down"],
    }

def reference(A_x, A_wqkv, A_wo, B_x, B_w_gate, B_w_up, B_w_down):
    def _A_ref(x, wqkv, wo):
        B, S, D = x.shape
        H = 16; Dh = D // H
        W, dil = 8, 2
        qkv = (lambda x, *d: x.permute(*d))((x @ wqkv).reshape(B, S, 3, H, Dh), 2, 0, 3, 1, 4)
        q, k, v = qkv[0], qkv[1], qkv[2]
        scale = Dh ** -0.5
        pos = torch.arange(S)
        off = torch.arange(W) * dil
        idx = pos[:, None] - off[None, :]
        mask = idx >= 0
        idx_c = torch.where(mask, idx, 0).reshape(-1)
        kg = k[:, :, idx_c, :].reshape(B, H, S, W, Dh)
        vg = v[:, :, idx_c, :].reshape(B, H, S, W, Dh)
        logits = torch.einsum("bhsd,bhswd->bhsw", q, kg) * scale
        logits = torch.where(mask[None, None, :, :], logits, -1e9)
        attn = _softmax(logits, axis=-1)
        o = torch.einsum("bhsw,bhswd->bhsd", attn, vg)
        return (lambda x, *d: x.permute(*d))(o, 0, 2, 1, 3).reshape(B, S, D) @ wo

    def _B_ref(x, w_gate, w_up, w_down):
        g = torch.einsum("bsd,df->bsf", x, w_gate)
        u = torch.einsum("bsd,df->bsf", x, w_up)
        h = g * u
        return torch.einsum("bsf,fd->bsd", h, w_down)

    x = A_x
    xn = _layernorm(x, axis=-1)
    return x + _A_ref(xn, A_wqkv, A_wo) + _B_ref(xn, B_w_gate, B_w_up, B_w_down)
```

```asm
; @launch grid=(256,1,1) block=(512,1,1) lds=163840
.amdgcn_target "amdgcn-amd-amdhsa--gfx950"
.text
.globl parallel_sum__sliding_local_dilated__glu_gated_bilinear__prompt_kernel
.p2align 8
.type parallel_sum__sliding_local_dilated__glu_gated_bilinear__prompt_kernel,@function
parallel_sum__sliding_local_dilated__glu_gated_bilinear__prompt_kernel:
  s_load_dwordx16 s[4:19], s[0:1], 0
  s_load_dwordx2 s[20:21], s[0:1], 72
  v_lshrrev_b32 v1, 6, v0
  v_and_b32 v0, 63, v0
  s_cmp_ge_u32 s2, 256
  s_cbranch_scc1 L_end
  v_readfirstlane_b32 s44, v1
  s_and_b32 s49, s2, 7
  s_lshr_b32 s50, s2, 3
  s_and_b32 s53, s49, 1
  s_lshl_b32 s53, s53, 3
  s_lshr_b32 s54, s50, 2
  s_add_u32 s45, s53, s54
  s_and_b32 s51, s50, 3
  s_lshr_b32 s53, s49, 1
  s_lshl_b32 s53, s53, 2
  s_add_u32 s46, s53, s51
  s_lshr_b32 s47, s46, 1
  s_lshl_b32 s53, s51, 1
  s_add_u32 s53, s53, s45
  s_mul_i32 s54, s53, 37
  s_lshr_b32 s54, s54, 8
  s_mul_i32 s54, s54, 7
  s_sub_u32 s48, s53, s54
  s_lshl_b32 s68, s45, 7
  s_mov_b32 s69, 0
  s_cmp_lt_u32 s44, 4
  s_cbranch_scc1 L_cmp
  s_cmp_ge_u32 s44, 6
  s_cbranch_scc1 L_h67
  s_sub_u32 s52, s44, 4
  v_lshrrev_b32 v1, 3, v0
  s_lshl_b32 s53, s52, 3
  v_add_u32 v1, s53, v1
  v_lshrrev_b32 v2, 1, v1
  v_and_b32 v2, 7, v2
  v_and_b32 v3, 7, v0
  v_xor_b32 v2, v2, v3
  v_lshlrev_b32 v2, 4, v2
  v_mul_u32_u24 v1, 896, v1
  v_add_u32 v10, v1, v2
  s_mul_i32 s74, s68, 896
  s_sub_u32 s73, s74, 14336
  s_cmp_eq_u32 s45, 0
  s_cselect_b32 s73, 0, s73
  s_lshl_b32 s72, s48, 7
  s_lshl_b32 s52, s52, 10
  s_add_u32 s75, s52, 82944
  s_mul_i32 s70, s48, 229376
  s_mul_i32 s71, s48, 172032
  s_waitcnt lgkmcnt(0)
  s_mov_b32 s32, s4
  s_mov_b32 s33, s5
  s_mov_b32 s34, 1835008
  s_mov_b32 s35, 0x20000
  s_add_u32 s58, s74, s72
  s_bitcmp1_b32 s46, 0
  s_cbranch_scc1 L_x0q
  s_add_u32 s59, s73, s72
  s_add_u32 m0, s75, 0
  s_add_u32 s56, s59, 0
  buffer_load_dwordx4 v10, s[32:35], s56 offen lds
L_x0q:
  s_add_u32 m0, s75, 2048
  s_add_u32 s56, s58, 0
  buffer_load_dwordx4 v10, s[32:35], s56 offen lds
  s_add_u32 m0, s75, 4096
  s_add_u32 s56, s58, 14336
  buffer_load_dwordx4 v10, s[32:35], s56 offen lds
  s_add_u32 m0, s75, 6144
  s_add_u32 s56, s58, 28672
  buffer_load_dwordx4 v10, s[32:35], s56 offen lds
  s_add_u32 m0, s75, 8192
  s_add_u32 s56, s58, 43008
  buffer_load_dwordx4 v10, s[32:35], s56 offen lds
  s_add_u32 m0, s75, 10240
  s_add_u32 s56, s58, 57344
  buffer_load_dwordx4 v10, s[32:35], s56 offen lds
  s_add_u32 m0, s75, 12288
  s_add_u32 s56, s58, 71680
  buffer_load_dwordx4 v10, s[32:35], s56 offen lds
  s_add_u32 m0, s75, 14336
  s_add_u32 s56, s58, 86016
  buffer_load_dwordx4 v10, s[32:35], s56 offen lds
  s_add_u32 m0, s75, 16384
  s_add_u32 s56, s58, 100352
  buffer_load_dwordx4 v10, s[32:35], s56 offen lds
  s_add_u32 s72, s72, 128
  s_cmp_eq_u32 s72, 896
  s_cselect_b32 s72, 0, s72
  s_add_u32 s75, s75, 18432
  s_cmp_ge_u32 s75, 138240
  s_cselect_b32 s59, 55296, 0
  s_sub_u32 s75, s75, s59
  s_mov_b32 s24, s12
  s_mov_b32 s25, s13
  s_mov_b32 s26, 1605632
  s_mov_b32 s27, 0x20000
  s_mov_b32 s28, s14
  s_mov_b32 s29, s15
  s_mov_b32 s30, 1605632
  s_mov_b32 s31, 0x20000
  s_mov_b32 s40, s20
  s_mov_b32 s41, s21
  s_mov_b32 s42, 12058624
  s_mov_b32 s43, 0x20000
  s_lshr_b32 s66, s50, 1
  s_bitcmp1_b32 s50, 0
  s_cselect_b32 s53, 0, 16
  s_add_u32 s66, s66, s53
  s_mul_i32 s53, s66, 37
  s_lshr_b32 s53, s53, 8
  s_mul_i32 s54, s53, 7
  s_sub_u32 s65, s66, s54
  s_lshl_b32 s64, s49, 2
  s_add_u32 s64, s64, s53
  s_and_b32 s53, s64, 3
  s_lshl_b32 s53, s53, 1
  s_and_b32 s54, s65, 1
  s_lshl_b32 s54, s54, 2
  s_add_u32 s53, s53, s54
  s_add_u32 s61, s44, s53
  s_and_b32 s61, s61, 7
  s_bitcmp1_b32 s46, 0
  s_cbranch_scc1 L_dmaQ
L_dmaP:
HOPSTART0:
HOP0:
  s_cbranch_execz HOP16
  s_mov_b32 s36, s6
  s_mov_b32 s37, s7
  s_mov_b32 s38, 1204224
  s_mov_b32 s39, 0x20000
  s_mul_i32 s54, s47, 112
  s_lshr_b32 s53, s52, 4
  s_add_u32 s53, s53, 0
  v_add_u32 v1, s53, v0
  v_mul_u32_u24 v2, 2731, v1
  v_lshrrev_b32 v2, 16, v2
  v_mul_u32_u24 v3, 24, v2
  v_sub_u32 v3, v1, v3
  v_lshrrev_b32 v4, 3, v3
  v_bfe_u32 v5, v3, 2, 1
  v_bfe_u32 v6, v2, 1, 1
  v_xor_b32 v5, v5, v6
  v_and_b32 v3, 3, v3
  v_bfe_u32 v6, v2, 3, 1
  v_lshlrev_b32 v6, 1, v6
  v_xor_b32 v3, v3, v6
  v_mul_u32_u24 v2, 2688, v2
  v_mul_u32_u24 v4, 896, v4
  v_mul_u32_u24 v5, 56, v5
  v_lshlrev_b32 v3, 4, v3
  v_add3_u32 v2, v2, v4, v5
  v_add3_u32 v11, v2, v3, s54
  s_lshr_b32 s53, s52, 4
  s_add_u32 s53, s53, 128
  v_add_u32 v1, s53, v0
  v_mul_u32_u24 v2, 2731, v1
  v_lshrrev_b32 v2, 16, v2
  v_mul_u32_u24 v3, 24, v2
  v_sub_u32 v3, v1, v3
  v_lshrrev_b32 v4, 3, v3
  v_bfe_u32 v5, v3, 2, 1
  v_bfe_u32 v6, v2, 1, 1
  v_xor_b32 v5, v5, v6
  v_and_b32 v3, 3, v3
  v_bfe_u32 v6, v2, 3, 1
  v_lshlrev_b32 v6, 1, v6
  v_xor_b32 v3, v3, v6
  v_mul_u32_u24 v2, 2688, v2
  v_mul_u32_u24 v4, 896, v4
HOPSTART1:
HOP1:
  s_cbranch_execz HOP17
  v_mul_u32_u24 v5, 56, v5
  v_lshlrev_b32 v3, 4, v3
  v_add3_u32 v2, v2, v4, v5
  v_add3_u32 v12, v2, v3, s54
  s_lshr_b32 s53, s52, 4
  s_add_u32 s53, s53, 256
  v_add_u32 v1, s53, v0
  v_mul_u32_u24 v2, 2731, v1
  v_lshrrev_b32 v2, 16, v2
  v_mul_u32_u24 v3, 24, v2
  v_sub_u32 v3, v1, v3
  v_lshrrev_b32 v4, 3, v3
  v_bfe_u32 v5, v3, 2, 1
  v_bfe_u32 v6, v2, 1, 1
  v_xor_b32 v5, v5, v6
  v_and_b32 v3, 3, v3
  v_bfe_u32 v6, v2, 3, 1
  v_lshlrev_b32 v6, 1, v6
  v_xor_b32 v3, v3, v6
  v_mul_u32_u24 v2, 2688, v2
  v_mul_u32_u24 v4, 896, v4
  v_mul_u32_u24 v5, 56, v5
  v_lshlrev_b32 v3, 4, v3
  v_add3_u32 v2, v2, v4, v5
  v_add3_u32 v13, v2, v3, s54
  s_lshr_b32 s53, s52, 7
  v_lshrrev_b32 v1, 3, v0
  v_add_u32 v1, s53, v1
  v_bfe_u32 v2, v1, 1, 1
  v_bfe_u32 v3, v0, 1, 2
  v_xor_b32 v2, v2, v3
  s_lshr_b32 s53, s52, 9
  v_xor_b32 v2, s53, v2
  v_lshlrev_b32 v2, 5, v2
  v_and_b32 v3, 1, v0
  v_lshlrev_b32 v3, 4, v3
  v_mul_u32_u24 v1, 3584, v1
  v_add3_u32 v1, v1, v2, v3
  s_lshl_b32 s54, s47, 7
  v_add_u32 v14, s54, v1
  v_lshlrev_b32 v16, 4, v0
  s_mov_b32 s69, -3
L_dlP:
  s_cmp_gt_i32 s69, 10
  s_cbranch_scc1 L_dzP1
  s_add_u32 m0, s52, 0
HOPSTART2:
HOP2:
  s_cbranch_execz HOP18
  s_add_u32 s56, s71, 0
  buffer_load_dwordx4 v11, s[36:39], s56 offen lds
  s_add_u32 m0, s52, 2048
  s_add_u32 s56, s71, 0
  buffer_load_dwordx4 v12, s[36:39], s56 offen lds
  s_add_u32 m0, s52, 4096
  s_add_u32 s56, s71, 0
  buffer_load_dwordx4 v13, s[36:39], s56 offen lds
  s_add_u32 m0, s52, 6144
  s_add_u32 s56, s71, 43008
  buffer_load_dwordx4 v11, s[36:39], s56 offen lds
  s_add_u32 m0, s52, 8192
  s_add_u32 s56, s71, 43008
  buffer_load_dwordx4 v12, s[36:39], s56 offen lds
  s_add_u32 m0, s52, 10240
  s_add_u32 s56, s71, 43008
  buffer_load_dwordx4 v13, s[36:39], s56 offen lds
  s_add_u32 m0, s52, 12288
  s_add_u32 s56, s70, 0
  buffer_load_dwordx4 v14, s[24:27], s56 offen lds
  s_add_u32 m0, s52, 14336
  s_add_u32 s56, s70, 57344
  buffer_load_dwordx4 v14, s[24:27], s56 offen lds
  s_add_u32 m0, s52, 16448
  s_add_u32 s56, s70, 0
  buffer_load_dwordx4 v14, s[28:31], s56 offen lds
  s_add_u32 m0, s52, 18496
  s_add_u32 s56, s70, 57344
  buffer_load_dwordx4 v14, s[28:31], s56 offen lds
  s_add_u32 s70, s70, 114688
  s_cmp_eq_u32 s70, 1605632
  s_cselect_b32 s70, 0, s70
  s_add_u32 s71, s71, 86016
HOPSTART3:
HOP3:
  s_cbranch_execz HOP19
  s_cmp_eq_u32 s71, 1204224
  s_cselect_b32 s71, 0, s71
L_dzP1:
L_dyP1:
  s_add_u32 s69, s69, 1
  s_cmp_eq_u32 s69, 14
  s_cbranch_scc1 L_dendP
  s_cmp_lt_i32 s69, 0
  s_cbranch_scc1 L_dnbP
  s_waitcnt vmcnt(14)
  s_barrier
L_dnbP:
  s_cmp_gt_i32 s69, 9
  s_cbranch_scc1 L_dxP2
  s_add_u32 s58, s74, s72
  s_add_u32 s59, s73, s72
  s_add_u32 m0, s75, 0
  s_add_u32 s56, s59, 0
  buffer_load_dwordx4 v10, s[32:35], s56 offen lds
  s_add_u32 m0, s75, 2048
  s_add_u32 s56, s58, 0
  buffer_load_dwordx4 v10, s[32:35], s56 offen lds
  s_add_u32 m0, s75, 4096
  s_add_u32 s56, s58, 14336
  buffer_load_dwordx4 v10, s[32:35], s56 offen lds
  s_add_u32 m0, s75, 6144
  s_add_u32 s56, s58, 28672
  buffer_load_dwordx4 v10, s[32:35], s56 offen lds
  s_add_u32 m0, s75, 8192
  s_add_u32 s56, s58, 43008
  buffer_load_dwordx4 v10, s[32:35], s56 offen lds
L_dxP2:
  s_cmp_gt_i32 s69, 10
  s_cbranch_scc1 L_dzP2
  s_add_u32 m0, s52, 20736
  s_add_u32 s56, s71, 0
  buffer_load_dwordx4 v11, s[36:39], s56 offen lds
  s_add_u32 m0, s52, 22784
  s_add_u32 s56, s71, 0
  buffer_load_dwordx4 v12, s[36:39], s56 offen lds
  s_add_u32 m0, s52, 24832
  s_add_u32 s56, s71, 0
  buffer_load_dwordx4 v13, s[36:39], s56 offen lds
  s_add_u32 m0, s52, 26880
HOPSTART4:
HOP4:
  s_cbranch_execz HOP20
  s_add_u32 s56, s71, 43008
  buffer_load_dwordx4 v11, s[36:39], s56 offen lds
  s_add_u32 m0, s52, 28928
  s_add_u32 s56, s71, 43008
  buffer_load_dwordx4 v12, s[36:39], s56 offen lds
  s_add_u32 m0, s52, 30976
  s_add_u32 s56, s71, 43008
  buffer_load_dwordx4 v13, s[36:39], s56 offen lds
  s_add_u32 m0, s52, 33024
  s_add_u32 s56, s70, 0
  buffer_load_dwordx4 v14, s[24:27], s56 offen lds
  s_add_u32 m0, s52, 35072
  s_add_u32 s56, s70, 57344
  buffer_load_dwordx4 v14, s[24:27], s56 offen lds
  s_add_u32 m0, s52, 37184
  s_add_u32 s56, s70, 0
  buffer_load_dwordx4 v14, s[28:31], s56 offen lds
  s_add_u32 m0, s52, 39232
  s_add_u32 s56, s70, 57344
  buffer_load_dwordx4 v14, s[28:31], s56 offen lds
  s_add_u32 s70, s70, 114688
  s_cmp_eq_u32 s70, 1605632
  s_cselect_b32 s70, 0, s70
  s_add_u32 s71, s71, 86016
  s_cmp_eq_u32 s71, 1204224
  s_cselect_b32 s71, 0, s71
L_dzP2:
L_dyP2:
  s_add_u32 s69, s69, 1
  s_cmp_eq_u32 s69, 11
  s_cbranch_scc0 L_dvP
  s_waitcnt vmcnt(10)
L_dvP:
  s_waitcnt vmcnt(15)
  s_barrier
  s_cmp_gt_i32 s69, 9
  s_cbranch_scc1 L_dxP3
  s_add_u32 m0, s75, 10240
  s_add_u32 s56, s58, 57344
HOPSTART5:
HOP5:
  s_cbranch_execz HOP21
  buffer_load_dwordx4 v10, s[32:35], s56 offen lds
  s_add_u32 m0, s75, 12288
  s_add_u32 s56, s58, 71680
  buffer_load_dwordx4 v10, s[32:35], s56 offen lds
  s_add_u32 m0, s75, 14336
  s_add_u32 s56, s58, 86016
  buffer_load_dwordx4 v10, s[32:35], s56 offen lds
  s_add_u32 m0, s75, 16384
  s_add_u32 s56, s58, 100352
  buffer_load_dwordx4 v10, s[32:35], s56 offen lds
  s_add_u32 s72, s72, 128
  s_cmp_eq_u32 s72, 896
  s_cselect_b32 s72, 0, s72
  s_add_u32 s75, s75, 18432
  s_cmp_ge_u32 s75, 138240
  s_cselect_b32 s59, 55296, 0
  s_sub_u32 s75, s75, s59
L_dxP3:
  s_cmp_gt_i32 s69, 10
  s_cbranch_scc1 L_dzP3
  s_add_u32 m0, s52, 41472
  s_add_u32 s56, s71, 0
  buffer_load_dwordx4 v11, s[36:39], s56 offen lds
  s_add_u32 m0, s52, 43520
  s_add_u32 s56, s71, 0
  buffer_load_dwordx4 v12, s[36:39], s56 offen lds
  s_add_u32 m0, s52, 45568
  s_add_u32 s56, s71, 0
  buffer_load_dwordx4 v13, s[36:39], s56 offen lds
  s_add_u32 m0, s52, 47616
  s_add_u32 s56, s71, 43008
  buffer_load_dwordx4 v11, s[36:39], s56 offen lds
  s_add_u32 m0, s52, 49664
  s_add_u32 s56, s71, 43008
  buffer_load_dwordx4 v12, s[36:39], s56 offen lds
HOPSTART6:
HOP6:
  s_cbranch_execz HOP22
  s_add_u32 m0, s52, 51712
  s_add_u32 s56, s71, 43008
  buffer_load_dwordx4 v13, s[36:39], s56 offen lds
  s_add_u32 m0, s52, 53760
  s_add_u32 s56, s70, 0
  buffer_load_dwordx4 v14, s[24:27], s56 offen lds
  s_add_u32 m0, s52, 55808
  s_add_u32 s56, s70, 57344
  buffer_load_dwordx4 v14, s[24:27], s56 offen lds
  s_add_u32 m0, s52, 57920
  s_add_u32 s56, s70, 0
  buffer_load_dwordx4 v14, s[28:31], s56 offen lds
  s_add_u32 m0, s52, 59968
  s_add_u32 s56, s70, 57344
  buffer_load_dwordx4 v14, s[28:31], s56 offen lds
  s_add_u32 s70, s70, 114688
  s_cmp_eq_u32 s70, 1605632
  s_cselect_b32 s70, 0, s70
  s_add_u32 s71, s71, 86016
  s_cmp_eq_u32 s71, 1204224
  s_cselect_b32 s71, 0, s71
  s_branch L_dyP3
L_dzP3:
  s_cmp_lt_u32 s66, 28
  s_cbranch_scc0 L_dyP3
  s_mul_i32 s53, s65, 72
  s_mul_i32 s54, s61, 5
  s_add_u32 s54, s54, 32
  s_add_u32 s54, s54, s53
  s_lshl_b32 s54, s54, 12
  s_add_u32 s80, s54, 9437184
  s_lshl_b32 s54, s61, 1
  s_add_u32 s54, s54, s53
  s_lshl_b32 s54, s54, 12
  s_add_u32 s81, s54, 9437184
  s_add_u32 s56, s80, 0
  buffer_load_dwordx4 v[176:179], v16, s[40:43], s56 offen offset:0 sc1
  buffer_load_dwordx4 v[180:183], v16, s[40:43], s56 offen offset:1024 sc1
  buffer_load_dwordx4 v[184:187], v16, s[40:43], s56 offen offset:2048 sc1
HOPSTART7:
HOP7:
  s_cbranch_execz HOP23
  buffer_load_dwordx4 v[188:191], v16, s[40:43], s56 offen offset:3072 sc1
  s_add_u32 s56, s80, 4096
  buffer_load_dwordx4 v[192:195], v16, s[40:43], s56 offen offset:0 sc1
  buffer_load_dwordx4 v[196:199], v16, s[40:43], s56 offen offset:1024 sc1
  buffer_load_dwordx4 v[200:203], v16, s[40:43], s56 offen offset:2048 sc1
  buffer_load_dwordx4 v[204:207], v16, s[40:43], s56 offen offset:3072 sc1
  s_add_u32 s56, s80, 8192
  buffer_load_dwordx4 v[208:211], v16, s[40:43], s56 offen offset:0 sc1
  buffer_load_dwordx4 v[212:215], v16, s[40:43], s56 offen offset:1024 sc1
  buffer_load_dwordx4 v[216:219], v16, s[40:43], s56 offen offset:2048 sc1
  buffer_load_dwordx4 v[220:223], v16, s[40:43], s56 offen offset:3072 sc1
  s_add_u32 s56, s80, 12288
  buffer_load_dwordx4 v[224:227], v16, s[40:43], s56 offen offset:0 sc1
  buffer_load_dwordx4 v[228:231], v16, s[40:43], s56 offen offset:1024 sc1
  buffer_load_dwordx4 v[232:235], v16, s[40:43], s56 offen offset:2048 sc1
  buffer_load_dwordx4 v[236:239], v16, s[40:43], s56 offen offset:3072 sc1
L_dyP3:
  s_add_u32 s69, s69, 1
  s_cmp_eq_u32 s69, 12
  s_cbranch_scc0 L_dwP
  s_cmp_lt_u32 s66, 28
  s_cbranch_scc1 L_dwbP
  s_waitcnt vmcnt(0)
L_dwbP:
  s_waitcnt vmcnt(16)
  s_barrier
  s_branch L_dwcP
L_dwP:
  s_waitcnt vmcnt(14)
  s_barrier
L_dwcP:
  s_cmp_gt_i32 s69, 9
  s_cbranch_scc1 L_dxP0
  s_add_u32 s58, s74, s72
  s_add_u32 s59, s73, s72
  s_add_u32 m0, s75, 0
  s_add_u32 s56, s59, 0
  buffer_load_dwordx4 v10, s[32:35], s56 offen lds
  s_add_u32 m0, s75, 2048
  s_add_u32 s56, s58, 0
  buffer_load_dwordx4 v10, s[32:35], s56 offen lds
  s_add_u32 m0, s75, 4096
  s_add_u32 s56, s58, 14336
HOPSTART8:
HOP8:
  s_cbranch_execz HOP24
  buffer_load_dwordx4 v10, s[32:35], s56 offen lds
  s_add_u32 m0, s75, 6144
  s_add_u32 s56, s58, 28672
  buffer_load_dwordx4 v10, s[32:35], s56 offen lds
  s_add_u32 m0, s75, 8192
  s_add_u32 s56, s58, 43008
  buffer_load_dwordx4 v10, s[32:35], s56 offen lds
L_dxP0:
  s_cmp_gt_i32 s69, 10
  s_cbranch_scc1 L_dzP0
  s_add_u32 m0, s52, 62208
  s_add_u32 s56, s71, 0
  buffer_load_dwordx4 v11, s[36:39], s56 offen lds
  s_add_u32 m0, s52, 64256
  s_add_u32 s56, s71, 0
  buffer_load_dwordx4 v12, s[36:39], s56 offen lds
  s_add_u32 m0, s52, 66304
  s_add_u32 s56, s71, 0
  buffer_load_dwordx4 v13, s[36:39], s56 offen lds
  s_add_u32 m0, s52, 68352
  s_add_u32 s56, s71, 43008
  buffer_load_dwordx4 v11, s[36:39], s56 offen lds
  s_add_u32 m0, s52, 70400
  s_add_u32 s56, s71, 43008
  buffer_load_dwordx4 v12, s[36:39], s56 offen lds
  s_add_u32 m0, s52, 72448
  s_add_u32 s56, s71, 43008
  buffer_load_dwordx4 v13, s[36:39], s56 offen lds
  s_add_u32 m0, s52, 74496
  s_add_u32 s56, s70, 0
  buffer_load_dwordx4 v14, s[24:27], s56 offen lds
  s_add_u32 m0, s52, 76544
  s_add_u32 s56, s70, 57344
  buffer_load_dwordx4 v14, s[24:27], s56 offen lds
HOPSTART9:
HOP9:
  s_cbranch_execz HOP25
  s_add_u32 m0, s52, 78656
  s_add_u32 s56, s70, 0
  buffer_load_dwordx4 v14, s[28:31], s56 offen lds
  s_add_u32 m0, s52, 80704
  s_add_u32 s56, s70, 57344
  buffer_load_dwordx4 v14, s[28:31], s56 offen lds
  s_add_u32 s70, s70, 114688
  s_cmp_eq_u32 s70, 1605632
  s_cselect_b32 s70, 0, s70
  s_add_u32 s71, s71, 86016
  s_cmp_eq_u32 s71, 1204224
  s_cselect_b32 s71, 0, s71
  s_branch L_dyP0
L_dzP0:
  s_cmp_lt_u32 s66, 28
  s_cbranch_scc0 L_dyP0
L_dyP0:
  s_add_u32 s69, s69, 1
  s_cmp_eq_u32 s69, 13
  s_cbranch_scc1 L_duP
  s_waitcnt vmcnt(15)
L_duP:
  s_barrier
  s_cmp_gt_i32 s69, 9
  s_cbranch_scc1 L_dxP1
  s_add_u32 m0, s75, 10240
  s_add_u32 s56, s58, 57344
  buffer_load_dwordx4 v10, s[32:35], s56 offen lds
  s_add_u32 m0, s75, 12288
  s_add_u32 s56, s58, 71680
  buffer_load_dwordx4 v10, s[32:35], s56 offen lds
  s_add_u32 m0, s75, 14336
  s_add_u32 s56, s58, 86016
  buffer_load_dwordx4 v10, s[32:35], s56 offen lds
  s_add_u32 m0, s75, 16384
  s_add_u32 s56, s58, 100352
  buffer_load_dwordx4 v10, s[32:35], s56 offen lds
  s_add_u32 s72, s72, 128
  s_cmp_eq_u32 s72, 896
  s_cselect_b32 s72, 0, s72
HOPSTART10:
HOP10:
  s_cbranch_execz HOP26
  s_add_u32 s75, s75, 18432
  s_cmp_ge_u32 s75, 138240
  s_cselect_b32 s59, 55296, 0
  s_sub_u32 s75, s75, s59
L_dxP1:
  s_branch L_dlP
L_dendP:
  s_branch L_tail_help
L_dmaQ:
HOPSTART11:
HOP11:
  s_cbranch_execz HOP27
  s_mul_i32 s54, s47, 320
  s_add_u32 s54, s54, 1024
  s_mul_i32 s55, s52, 56
  s_add_u32 s54, s54, s55
  s_mul_i32 s57, s52, 5
  v_add_u32 v1, 0, v0
  v_mul_u32_u24 v2, 3277, v1
  v_lshrrev_b32 v2, 16, v2
  v_mul_u32_u24 v3, 20, v2
  v_sub_u32 v3, v1, v3
  v_bfe_u32 v4, v2, 3, 1
  v_lshlrev_b32 v4, 1, v4
  v_xor_b32 v3, v3, v4
  v_lshlrev_b32 v3, 4, v3
  v_mul_u32_u24 v2, 3584, v2
  v_add3_u32 v11, v2, v3, s54
  v_add_u32 v1, 64, v0
  v_mul_u32_u24 v2, 3277, v1
  v_lshrrev_b32 v2, 16, v2
  v_mul_u32_u24 v3, 20, v2
  v_sub_u32 v3, v1, v3
  v_bfe_u32 v4, v2, 3, 1
  v_lshlrev_b32 v4, 1, v4
  v_xor_b32 v3, v3, v4
  v_lshlrev_b32 v3, 4, v3
  v_mul_u32_u24 v2, 3584, v2
  v_add3_u32 v12, v2, v3, s54
  v_add_u32 v1, 128, v0
  v_mul_u32_u24 v2, 3277, v1
  v_lshrrev_b32 v2, 16, v2
  v_mul_u32_u24 v3, 20, v2
  v_sub_u32 v3, v1, v3
  v_bfe_u32 v4, v2, 3, 1
  v_lshlrev_b32 v4, 1, v4
  v_xor_b32 v3, v3, v4
  v_lshlrev_b32 v3, 4, v3
  v_mul_u32_u24 v2, 3584, v2
  v_add3_u32 v13, v2, v3, s54
  v_add_u32 v1, 192, v0
  v_mul_u32_u24 v2, 3277, v1
  v_lshrrev_b32 v2, 16, v2
  v_mul_u32_u24 v3, 20, v2
  v_sub_u32 v3, v1, v3
HOPSTART12:
HOP12:
  s_cbranch_execz HOP28
  v_bfe_u32 v4, v2, 3, 1
  v_lshlrev_b32 v4, 1, v4
  v_xor_b32 v3, v3, v4
  v_lshlrev_b32 v3, 4, v3
  v_mul_u32_u24 v2, 3584, v2
  v_add3_u32 v14, v2, v3, s54
  v_add_u32 v1, 256, v0
  v_mul_u32_u24 v2, 3277, v1
  v_lshrrev_b32 v2, 16, v2
  v_mul_u32_u24 v3, 20, v2
  v_sub_u32 v3, v1, v3
  v_bfe_u32 v4, v2, 3, 1
  v_lshlrev_b32 v4, 1, v4
  v_xor_b32 v3, v3, v4
  v_lshlrev_b32 v3, 4, v3
  v_mul_u32_u24 v2, 3584, v2
  v_add3_u32 v15, v2, v3, s54
  v_lshlrev_b32 v16, 4, v0
  s_mov_b32 s69, -3
L_dlQ:
  s_cmp_gt_i32 s69, 10
  s_cbranch_scc1 L_dzQ1
  s_add_u32 m0, s57, 0
  s_nop 0
  buffer_load_dwordx4 v11, s[24:27], s70 offen lds
  s_add_u32 m0, s57, 1024
  s_nop 0
  buffer_load_dwordx4 v12, s[24:27], s70 offen lds
  s_add_u32 m0, s57, 2048
  s_nop 0
  buffer_load_dwordx4 v13, s[24:27], s70 offen lds
  s_add_u32 m0, s57, 3072
  s_nop 0
  buffer_load_dwordx4 v14, s[24:27], s70 offen lds
  s_add_u32 m0, s57, 4096
  s_nop 0
  buffer_load_dwordx4 v15, s[24:27], s70 offen lds
  s_add_u32 m0, s57, 10272
  s_nop 0
  buffer_load_dwordx4 v11, s[28:31], s70 offen lds
  s_add_u32 m0, s57, 11296
HOPSTART13:
HOP13:
  s_cbranch_execz HOP29
  s_nop 0
  buffer_load_dwordx4 v12, s[28:31], s70 offen lds
  s_add_u32 m0, s57, 12320
  s_nop 0
  buffer_load_dwordx4 v13, s[28:31], s70 offen lds
  s_add_u32 m0, s57, 13344
  s_nop 0
  buffer_load_dwordx4 v14, s[28:31], s70 offen lds
  s_add_u32 m0, s57, 14368
  s_nop 0
  buffer_load_dwordx4 v15, s[28:31], s70 offen lds
  s_add_u32 s70, s70, 114688
  s_cmp_eq_u32 s70, 1605632
  s_cselect_b32 s70, 0, s70
L_dzQ1:
L_dyQ1:
  s_add_u32 s69, s69, 1
  s_cmp_eq_u32 s69, 14
  s_cbranch_scc1 L_dendQ
  s_cmp_lt_i32 s69, 0
  s_cbranch_scc1 L_dnbQ
  s_waitcnt vmcnt(14)
  s_barrier
L_dnbQ:
  s_cmp_gt_i32 s69, 9
  s_cbranch_scc1 L_dxQ2
  s_add_u32 s58, s74, s72
  s_add_u32 m0, s75, 2048
  s_add_u32 s56, s58, 0
  buffer_load_dwordx4 v10, s[32:35], s56 offen lds
  s_add_u32 m0, s75, 4096
  s_add_u32 s56, s58, 14336
  buffer_load_dwordx4 v10, s[32:35], s56 offen lds
  s_add_u32 m0, s75, 6144
  s_add_u32 s56, s58, 28672
  buffer_load_dwordx4 v10, s[32:35], s56 offen lds
  s_add_u32 m0, s75, 8192
  s_add_u32 s56, s58, 43008
  buffer_load_dwordx4 v10, s[32:35], s56 offen lds
L_dxQ2:
  s_cmp_gt_i32 s69, 10
  s_cbranch_scc1 L_dzQ2
  s_add_u32 m0, s57, 20736
HOPSTART14:
HOP14:
  s_cbranch_execz HOP30
  s_nop 0
  buffer_load_dwordx4 v11, s[24:27], s70 offen lds
  s_add_u32 m0, s57, 21760
  s_nop 0
  buffer_load_dwordx4 v12, s[24:27], s70 offen lds
  s_add_u32 m0, s57, 22784
  s_nop 0
  buffer_load_dwordx4 v13, s[24:27], s70 offen lds
  s_add_u32 m0, s57, 23808
  s_nop 0
  buffer_load_dwordx4 v14, s[24:27], s70 offen lds
  s_add_u32 m0, s57, 24832
  s_nop 0
  buffer_load_dwordx4 v15, s[24:27], s70 offen lds
  s_add_u32 m0, s57, 31008
  s_nop 0
  buffer_load_dwordx4 v11, s[28:31], s70 offen lds
  s_add_u32 m0, s57, 32032
  s_nop 0
  buffer_load_dwordx4 v12, s[28:31], s70 offen lds
  s_add_u32 m0, s57, 33056
  s_nop 0
  buffer_load_dwordx4 v13, s[28:31], s70 offen lds
  s_add_u32 m0, s57, 34080
  s_nop 0
  buffer_load_dwordx4 v14, s[28:31], s70 offen lds
  s_add_u32 m0, s57, 35104
  s_nop 0
  buffer_load_dwordx4 v15, s[28:31], s70 offen lds
  s_add_u32 s70, s70, 114688
  s_cmp_eq_u32 s70, 1605632
  s_cselect_b32 s70, 0, s70
L_dzQ2:
L_dyQ2:
  s_add_u32 s69, s69, 1
  s_cmp_eq_u32 s69, 11
  s_cbranch_scc0 L_dvQ
  s_waitcnt vmcnt(10)
L_dvQ:
  s_waitcnt vmcnt(14)
  s_barrier
  s_cmp_gt_i32 s69, 9
HOPSTART15:
HOP15:
  s_cbranch_execz HOP31
  s_cbranch_scc1 L_dxQ3
  s_add_u32 m0, s75, 10240
  s_add_u32 s56, s58, 57344
  buffer_load_dwordx4 v10, s[32:35], s56 offen lds
  s_add_u32 m0, s75, 12288
  s_add_u32 s56, s58, 71680
  buffer_load_dwordx4 v10, s[32:35], s56 offen lds
  s_add_u32 m0, s75, 14336
  s_add_u32 s56, s58, 86016
  buffer_load_dwordx4 v10, s[32:35], s56 offen lds
  s_add_u32 m0, s75, 16384
  s_add_u32 s56, s58, 100352
  buffer_load_dwordx4 v10, s[32:35], s56 offen lds
  s_add_u32 s72, s72, 128
  s_cmp_eq_u32 s72, 896
  s_cselect_b32 s72, 0, s72
  s_add_u32 s75, s75, 18432
  s_cmp_ge_u32 s75, 138240
  s_cselect_b32 s59, 55296, 0
  s_sub_u32 s75, s75, s59
L_dxQ3:
  s_cmp_gt_i32 s69, 10
  s_cbranch_scc1 L_dzQ3
  s_add_u32 m0, s57, 41472
  s_nop 0
  buffer_load_dwordx4 v11, s[24:27], s70 offen lds
  s_add_u32 m0, s57, 42496
  s_nop 0
  buffer_load_dwordx4 v12, s[24:27], s70 offen lds
  s_add_u32 m0, s57, 43520
  s_nop 0
  buffer_load_dwordx4 v13, s[24:27], s70 offen lds
  s_add_u32 m0, s57, 44544
  s_nop 0
  buffer_load_dwordx4 v14, s[24:27], s70 offen lds
  s_add_u32 m0, s57, 45568
HOP16:
  s_cbranch_execz HOP32
  s_nop 0
  buffer_load_dwordx4 v15, s[24:27], s70 offen lds
  s_add_u32 m0, s57, 51744
  s_nop 0
  buffer_load_dwordx4 v11, s[28:31], s70 offen lds
  s_add_u32 m0, s57, 52768
  s_nop 0
  buffer_load_dwordx4 v12, s[28:31], s70 offen lds
  s_add_u32 m0, s57, 53792
  s_nop 0
  buffer_load_dwordx4 v13, s[28:31], s70 offen lds
  s_add_u32 m0, s57, 54816
  s_nop 0
  buffer_load_dwordx4 v14, s[28:31], s70 offen lds
  s_add_u32 m0, s57, 55840
  s_nop 0
  buffer_load_dwordx4 v15, s[28:31], s70 offen lds
  s_add_u32 s70, s70, 114688
  s_cmp_eq_u32 s70, 1605632
  s_cselect_b32 s70, 0, s70
  s_branch L_dyQ3
L_dzQ3:
  s_cmp_lt_u32 s66, 28
  s_cbranch_scc0 L_dyQ3
  s_mul_i32 s53, s65, 72
  s_mul_i32 s54, s61, 5
  s_add_u32 s54, s54, 32
  s_add_u32 s54, s54, s53
  s_lshl_b32 s54, s54, 12
  s_add_u32 s80, s54, 9437184
  s_lshl_b32 s54, s61, 1
  s_add_u32 s54, s54, s53
  s_lshl_b32 s54, s54, 12
  s_add_u32 s81, s54, 9437184
  s_add_u32 s56, s80, 0
  buffer_load_dwordx4 v[176:179], v16, s[40:43], s56 offen offset:0 sc1
  buffer_load_dwordx4 v[180:183], v16, s[40:43], s56 offen offset:1024 sc1
  buffer_load_dwordx4 v[184:187], v16, s[40:43], s56 offen offset:2048 sc1
  buffer_load_dwordx4 v[188:191], v16, s[40:43], s56 offen offset:3072 sc1
  s_add_u32 s56, s80, 4096
HOP17:
  s_cbranch_execz HOP33
  buffer_load_dwordx4 v[192:195], v16, s[40:43], s56 offen offset:0 sc1
  buffer_load_dwordx4 v[196:199], v16, s[40:43], s56 offen offset:1024 sc1
  buffer_load_dwordx4 v[200:203], v16, s[40:43], s56 offen offset:2048 sc1
  buffer_load_dwordx4 v[204:207], v16, s[40:43], s56 offen offset:3072 sc1
  s_add_u32 s56, s80, 8192
  buffer_load_dwordx4 v[208:211], v16, s[40:43], s56 offen offset:0 sc1
  buffer_load_dwordx4 v[212:215], v16, s[40:43], s56 offen offset:1024 sc1
  buffer_load_dwordx4 v[216:219], v16, s[40:43], s56 offen offset:2048 sc1
  buffer_load_dwordx4 v[220:223], v16, s[40:43], s56 offen offset:3072 sc1
  s_add_u32 s56, s80, 12288
  buffer_load_dwordx4 v[224:227], v16, s[40:43], s56 offen offset:0 sc1
  buffer_load_dwordx4 v[228:231], v16, s[40:43], s56 offen offset:1024 sc1
  buffer_load_dwordx4 v[232:235], v16, s[40:43], s56 offen offset:2048 sc1
  buffer_load_dwordx4 v[236:239], v16, s[40:43], s56 offen offset:3072 sc1
L_dyQ3:
  s_add_u32 s69, s69, 1
  s_cmp_eq_u32 s69, 12
  s_cbranch_scc0 L_dwQ
  s_cmp_lt_u32 s66, 28
  s_cbranch_scc1 L_dwbQ
  s_waitcnt vmcnt(0)
L_dwbQ:
  s_waitcnt vmcnt(16)
  s_barrier
  s_branch L_dwcQ
L_dwQ:
  s_waitcnt vmcnt(14)
  s_barrier
L_dwcQ:
  s_cmp_gt_i32 s69, 9
  s_cbranch_scc1 L_dxQ0
  s_add_u32 s58, s74, s72
  s_add_u32 m0, s75, 2048
  s_add_u32 s56, s58, 0
  buffer_load_dwordx4 v10, s[32:35], s56 offen lds
  s_add_u32 m0, s75, 4096
  s_add_u32 s56, s58, 14336
  buffer_load_dwordx4 v10, s[32:35], s56 offen lds
  s_add_u32 m0, s75, 6144
  s_add_u32 s56, s58, 28672
  buffer_load_dwordx4 v10, s[32:35], s56 offen lds
  s_add_u32 m0, s75, 8192
HOP18:
  s_cbranch_execz HOP34
  s_add_u32 s56, s58, 43008
  buffer_load_dwordx4 v10, s[32:35], s56 offen lds
L_dxQ0:
  s_cmp_gt_i32 s69, 10
  s_cbranch_scc1 L_dzQ0
  s_add_u32 m0, s57, 62208
  s_nop 0
  buffer_load_dwordx4 v11, s[24:27], s70 offen lds
  s_add_u32 m0, s57, 63232
  s_nop 0
  buffer_load_dwordx4 v12, s[24:27], s70 offen lds
  s_add_u32 m0, s57, 64256
  s_nop 0
  buffer_load_dwordx4 v13, s[24:27], s70 offen lds
  s_add_u32 m0, s57, 65280
  s_nop 0
  buffer_load_dwordx4 v14, s[24:27], s70 offen lds
  s_add_u32 m0, s57, 66304
  s_nop 0
  buffer_load_dwordx4 v15, s[24:27], s70 offen lds
  s_add_u32 m0, s57, 72480
  s_nop 0
  buffer_load_dwordx4 v11, s[28:31], s70 offen lds
  s_add_u32 m0, s57, 73504
  s_nop 0
  buffer_load_dwordx4 v12, s[28:31], s70 offen lds
  s_add_u32 m0, s57, 74528
  s_nop 0
  buffer_load_dwordx4 v13, s[28:31], s70 offen lds
  s_add_u32 m0, s57, 75552
  s_nop 0
  buffer_load_dwordx4 v14, s[28:31], s70 offen lds
  s_add_u32 m0, s57, 76576
  s_nop 0
  buffer_load_dwordx4 v15, s[28:31], s70 offen lds
  s_add_u32 s70, s70, 114688
  s_cmp_eq_u32 s70, 1605632
HOP19:
  s_cbranch_execz HOP35
  s_cselect_b32 s70, 0, s70
  s_branch L_dyQ0
L_dzQ0:
  s_cmp_lt_u32 s66, 28
  s_cbranch_scc0 L_dyQ0
L_dyQ0:
  s_add_u32 s69, s69, 1
  s_cmp_eq_u32 s69, 13
  s_cbranch_scc1 L_duQ
  s_waitcnt vmcnt(14)
L_duQ:
  s_barrier
  s_cmp_gt_i32 s69, 9
  s_cbranch_scc1 L_dxQ1
  s_add_u32 m0, s75, 10240
  s_add_u32 s56, s58, 57344
  buffer_load_dwordx4 v10, s[32:35], s56 offen lds
  s_add_u32 m0, s75, 12288
  s_add_u32 s56, s58, 71680
  buffer_load_dwordx4 v10, s[32:35], s56 offen lds
  s_add_u32 m0, s75, 14336
  s_add_u32 s56, s58, 86016
  buffer_load_dwordx4 v10, s[32:35], s56 offen lds
  s_add_u32 m0, s75, 16384
  s_add_u32 s56, s58, 100352
  buffer_load_dwordx4 v10, s[32:35], s56 offen lds
  s_add_u32 s72, s72, 128
  s_cmp_eq_u32 s72, 896
  s_cselect_b32 s72, 0, s72
  s_add_u32 s75, s75, 18432
  s_cmp_ge_u32 s75, 138240
  s_cselect_b32 s59, 55296, 0
  s_sub_u32 s75, s75, s59
L_dxQ1:
  s_branch L_dlQ
L_dendQ:
  s_branch L_tail_help
L_cmp:
  s_lshl_b32 s53, s51, 2
  s_add_u32 s53, s53, s44
  s_mov_b64 s[62:63], exec
  s_mov_b64 exec, 0
  s_cmp_eq_u32 s53, 0
  s_cbranch_scc1 HOPSTART0
  s_cmp_eq_u32 s53, 1
  s_cbranch_scc1 HOPSTART1
  s_cmp_eq_u32 s53, 2
  s_cbranch_scc1 HOPSTART2
  s_cmp_eq_u32 s53, 3
  s_cbranch_scc1 HOPSTART3
  s_cmp_eq_u32 s53, 4
  s_cbranch_scc1 HOPSTART4
  s_cmp_eq_u32 s53, 5
  s_cbranch_scc1 HOPSTART5
  s_cmp_eq_u32 s53, 6
  s_cbranch_scc1 HOPSTART6
  s_cmp_eq_u32 s53, 7
  s_cbranch_scc1 HOPSTART7
  s_cmp_eq_u32 s53, 8
  s_cbranch_scc1 HOPSTART8
  s_cmp_eq_u32 s53, 9
  s_cbranch_scc1 HOPSTART9
  s_cmp_eq_u32 s53, 10
  s_cbranch_scc1 HOPSTART10
  s_cmp_eq_u32 s53, 11
  s_cbranch_scc1 HOPSTART11
  s_cmp_eq_u32 s53, 12
  s_cbranch_scc1 HOPSTART12
  s_cmp_eq_u32 s53, 13
  s_cbranch_scc1 HOPSTART13
  s_cmp_eq_u32 s53, 14
  s_cbranch_scc1 HOPSTART14
  s_cmp_eq_u32 s53, 15
  s_cbranch_scc1 HOPSTART15
L_hopret:
  s_mov_b64 exec, s[62:63]
  s_and_b32 s70, s44, 1
  s_lshr_b32 s71, s44, 1
  v_lshrrev_b32 v20, 4, v0
  v_bfe_u32 v21, v0, 2, 2
  v_and_b32 v22, 3, v0
  v_lshlrev_b32 v22, 3, v22
  v_lshrrev_b32 v23, 1, v21
  v_and_b32 v24, 1, v20
  v_lshlrev_b32 v25, 3, v20
  v_add_u32 v25, v25, v21
  v_and_b32 v26, 15, v0
  v_lshrrev_b32 v27, 1, v26
  v_lshlrev_b32 v26, 7, v26
  v_add_u32 v26, 82944, v26
  v_xor_b32 v28, v20, v27
  v_lshlrev_b32 v28, 4, v28
  v_add_u32 v3, v26, v28
  v_add_u32 v28, 4, v20
  v_xor_b32 v28, v28, v27
  v_lshlrev_b32 v28, 4, v28
  v_add_u32 v4, v26, v28
  s_lshl_b32 s53, s70, 13
  s_add_u32 s53, s53, 2048
  v_add_u32 v1, s53, v3
  v_add_u32 v2, s53, v4
  v_mov_b64 v[96:97], 0
  v_mov_b64 v[98:99], 0
  v_mov_b64 v[100:101], 0
  v_mov_b64 v[102:103], 0
  v_mov_b64 v[104:105], 0
  v_mov_b64 v[106:107], 0
  v_mov_b64 v[108:109], 0
  v_mov_b64 v[110:111], 0
  v_mov_b64 v[112:113], 0
  v_mov_b64 v[114:115], 0
  v_mov_b64 v[116:117], 0
  v_mov_b64 v[118:119], 0
  v_mov_b64 v[120:121], 0
  v_mov_b64 v[122:123], 0
  v_mov_b64 v[124:125], 0
  v_mov_b64 v[126:127], 0
  v_mov_b64 v[128:129], 0
  v_mov_b64 v[130:131], 0
  v_mov_b64 v[132:133], 0
  v_mov_b64 v[134:135], 0
  v_mov_b64 v[136:137], 0
  v_mov_b64 v[138:139], 0
  v_mov_b64 v[140:141], 0
  v_mov_b64 v[142:143], 0
  v_mov_b64 v[144:145], 0
  v_mov_b64 v[146:147], 0
  v_mov_b64 v[148:149], 0
  v_mov_b64 v[150:151], 0
  v_mov_b64 v[152:153], 0
  v_mov_b64 v[154:155], 0
  v_mov_b64 v[156:157], 0
  v_mov_b64 v[158:159], 0
  v_mov_b64 v[160:161], 0
  v_mov_b64 v[162:163], 0
  v_mov_b64 v[164:165], 0
  v_mov_b64 v[166:167], 0
  v_mov_b64 v[168:169], 0
  v_mov_b64 v[170:171], 0
  v_mov_b64 v[172:173], 0
  v_mov_b64 v[174:175], 0
  v_mov_b64 v[176:177], 0
  v_mov_b64 v[178:179], 0
  v_mov_b64 v[180:181], 0
  v_mov_b64 v[182:183], 0
  v_mov_b64 v[184:185], 0
  v_mov_b64 v[186:187], 0
  v_mov_b64 v[188:189], 0
  v_mov_b64 v[190:191], 0
  v_mov_b64 v[192:193], 0
  v_mov_b64 v[194:195], 0
  v_mov_b64 v[196:197], 0
  v_mov_b64 v[198:199], 0
  v_mov_b64 v[200:201], 0
  v_mov_b64 v[202:203], 0
  v_mov_b64 v[204:205], 0
  v_mov_b64 v[206:207], 0
  v_mov_b64 v[208:209], 0
  v_mov_b64 v[210:211], 0
  v_mov_b64 v[212:213], 0
  v_mov_b64 v[214:215], 0
  v_mov_b64 v[216:217], 0
  v_mov_b64 v[218:219], 0
  v_mov_b64 v[220:221], 0
  v_mov_b64 v[222:223], 0
  v_mov_b64 v[224:225], 0
  v_mov_b64 v[226:227], 0
  v_mov_b64 v[228:229], 0
  v_mov_b64 v[230:231], 0
  v_mov_b64 v[232:233], 0
  v_mov_b64 v[234:235], 0
  v_mov_b64 v[236:237], 0
  v_mov_b64 v[238:239], 0
  v_mov_b64 v[240:241], 0
  v_mov_b64 v[242:243], 0
  v_mov_b64 v[244:245], 0
  v_mov_b64 v[246:247], 0
  v_mov_b64 v[248:249], 0
  v_mov_b64 v[250:251], 0
  v_mov_b64 v[252:253], 0
  v_mov_b64 v[254:255], 0
  v_mov_b64 v[88:89], 0
  v_mov_b64 v[90:91], 0
  v_mov_b64 v[92:93], 0
  v_mov_b64 v[94:95], 0
  s_waitcnt lgkmcnt(0)
  s_mov_b32 s40, s20
  s_mov_b32 s41, s21
  s_mov_b32 s42, 12058624
  s_mov_b32 s43, 0x20000
  s_lshr_b32 s66, s50, 1
  s_bitcmp1_b32 s50, 0
  s_cselect_b32 s53, 0, 16
  s_add_u32 s66, s66, s53
  s_mul_i32 s53, s66, 37
  s_lshr_b32 s53, s53, 8
  s_mul_i32 s54, s53, 7
  s_sub_u32 s65, s66, s54
  s_lshl_b32 s64, s49, 2
  s_add_u32 s64, s64, s53
  s_and_b32 s53, s64, 3
  s_lshl_b32 s53, s53, 1
  s_and_b32 s54, s65, 1
  s_lshl_b32 s54, s54, 2
  s_add_u32 s53, s53, s54
  s_add_u32 s61, s44, s53
  s_and_b32 s61, s61, 7
  s_bitcmp1_b32 s46, 0
  s_cbranch_scc1 L_cmpQ
L_cmpP:
  v_mul_u32_u24 v26, 384, v25
  v_xor_b32 v27, s71, v23
  v_lshlrev_b32 v27, 6, v27
  v_add3_u32 v26, v26, v27, v22
  v_lshlrev_b32 v27, 5, v24
  v_add_u32 v5, v26, v27
  v_sub_u32 v6, v26, v27
  v_add_u32 v6, 32, v6
  v_lshlrev_b32 v26, 7, v25
  v_xor_b32 v27, s71, v24
  v_lshlrev_b32 v27, 6, v27
  v_add3_u32 v26, v26, v27, v22
  v_lshlrev_b32 v27, 5, v23
  v_add_u32 v7, v26, v27
  v_sub_u32 v8, v26, v27
  v_add_u32 v8, 32, v8
  s_mov_b32 s72, 0
  s_mov_b32 s76, 18432
  s_mov_b32 s77, -36864
  s_mov_b32 s80, 20736
  s_mov_b32 s79, 20736
  s_mov_b32 s81, 4294925312
  s_barrier
  ds_read_b128 v[12:15], v1 offset:0
  ds_read_b128 v[16:19], v1 offset:2048
  ds_read_b128 v[20:23], v1 offset:4096
  ds_read_b128 v[24:27], v1 offset:6144
  ds_read_b64_tr_b16 v[44:45], v7 offset:12288
  ds_read_b64_tr_b16 v[46:47], v7 offset:12800
  ds_read_b64_tr_b16 v[48:49], v7 offset:16448
  ds_read_b64_tr_b16 v[50:51], v7 offset:16960
  ds_read_b64_tr_b16 v[52:53], v8 offset:12288
  ds_read_b64_tr_b16 v[54:55], v8 offset:12800
  ds_read_b64_tr_b16 v[68:69], v5 offset:128
  ds_read_b64_tr_b16 v[70:71], v5 offset:1664
  ds_read_b64_tr_b16 v[72:73], v6 offset:128
  ds_read_b64_tr_b16 v[74:75], v6 offset:1664
  ds_read_b64_tr_b16 v[76:77], v5 offset:256
  ds_read_b64_tr_b16 v[78:79], v5 offset:1792
  ds_read_b64_tr_b16 v[80:81], v6 offset:256
  ds_read_b64_tr_b16 v[82:83], v6 offset:1792
  ds_read_b128 v[84:87], v3
  ds_read_b64_tr_b16 v[60:61], v5 offset:0
  ds_read_b64_tr_b16 v[62:63], v5 offset:1536
  s_cmp_eq_u32 s70, 0
  s_cbranch_scc0 L_clP1
L_clP0:
  s_waitcnt lgkmcnt(11)
  v_mfma_f32_16x16x32_bf16 v[96:99], v[44:47], v[12:15], v[96:99]
  ds_read_b64_tr_b16 v[64:65], v6 offset:0
  v_mfma_f32_16x16x32_bf16 v[100:103], v[44:47], v[16:19], v[100:103]
  ds_read_b64_tr_b16 v[66:67], v6 offset:1536
  v_mfma_f32_16x16x32_bf16 v[104:107], v[44:47], v[20:23], v[104:107]
  ds_read_b64_tr_b16 v[56:57], v8 offset:16448
  v_mfma_f32_16x16x32_bf16 v[108:111], v[44:47], v[24:27], v[108:111]
  ds_read_b64_tr_b16 v[58:59], v8 offset:16960
  v_mfma_f32_16x16x32_bf16 v[112:115], v[48:51], v[12:15], v[112:115]
  v_add_u32 v5, s80, v5
  v_mfma_f32_16x16x32_bf16 v[116:119], v[48:51], v[16:19], v[116:119]
  v_add_u32 v6, s80, v6
  v_mfma_f32_16x16x32_bf16 v[120:123], v[48:51], v[20:23], v[120:123]
  v_add_u32 v7, s80, v7
  v_mfma_f32_16x16x32_bf16 v[124:127], v[48:51], v[24:27], v[124:127]
  v_add_u32 v8, s80, v8
  v_mfma_f32_16x16x32_bf16 v[128:131], v[52:55], v[12:15], v[128:131]
  v_mfma_f32_16x16x32_bf16 v[132:135], v[52:55], v[16:19], v[132:135]
  v_mfma_f32_16x16x32_bf16 v[136:139], v[52:55], v[20:23], v[136:139]
  v_mfma_f32_16x16x32_bf16 v[140:143], v[52:55], v[24:27], v[140:143]
  s_waitcnt lgkmcnt(0)
  s_barrier
  v_mfma_f32_16x16x32_bf16 v[192:195], v[68:71], v[12:15], v[192:195]
  ds_read_b128 v[28:31], v2 offset:0
  v_mfma_f32_16x16x32_bf16 v[196:199], v[68:71], v[16:19], v[196:199]
  ds_read_b128 v[32:35], v2 offset:2048
  v_mfma_f32_16x16x32_bf16 v[200:203], v[68:71], v[20:23], v[200:203]
  ds_read_b128 v[36:39], v2 offset:4096
  v_mfma_f32_16x16x32_bf16 v[204:207], v[68:71], v[24:27], v[204:207]
  ds_read_b128 v[40:43], v2 offset:6144
  v_mfma_f32_16x16x32_bf16 v[208:211], v[72:75], v[12:15], v[208:211]
  ds_read_b64_tr_b16 v[44:45], v7 offset:12288
  v_mfma_f32_16x16x32_bf16 v[212:215], v[72:75], v[16:19], v[212:215]
  ds_read_b64_tr_b16 v[46:47], v7 offset:12800
  v_mfma_f32_16x16x32_bf16 v[216:219], v[72:75], v[20:23], v[216:219]
  ds_read_b64_tr_b16 v[48:49], v7 offset:16448
  v_mfma_f32_16x16x32_bf16 v[220:223], v[72:75], v[24:27], v[220:223]
  ds_read_b64_tr_b16 v[50:51], v7 offset:16960
  v_mfma_f32_16x16x32_bf16 v[224:227], v[12:15], v[76:79], v[224:227]
  ds_read_b64_tr_b16 v[52:53], v8 offset:12288
  v_mfma_f32_16x16x32_bf16 v[228:231], v[16:19], v[76:79], v[228:231]
  ds_read_b64_tr_b16 v[54:55], v8 offset:12800
  v_mfma_f32_16x16x32_bf16 v[232:235], v[20:23], v[76:79], v[232:235]
  s_add_u32 s72, s72, 1
  v_mfma_f32_16x16x32_bf16 v[236:239], v[24:27], v[76:79], v[236:239]
  s_cmp_eq_u32 s72, 3
  v_mfma_f32_16x16x32_bf16 v[240:243], v[12:15], v[80:83], v[240:243]
  s_cselect_b32 s73, s77, s76
  v_mfma_f32_16x16x32_bf16 v[244:247], v[16:19], v[80:83], v[244:247]
  s_cselect_b32 s72, 0, s72
  v_mfma_f32_16x16x32_bf16 v[248:251], v[20:23], v[80:83], v[248:251]
  v_mfma_f32_16x16x32_bf16 v[252:255], v[24:27], v[80:83], v[252:255]
  v_mfma_f32_16x16x32_bf16 v[88:91], v[68:71], v[84:87], v[88:91]
  v_mfma_f32_16x16x32_bf16 v[92:95], v[72:75], v[84:87], v[92:95]
  v_mfma_f32_16x16x32_bf16 v[144:147], v[56:59], v[12:15], v[144:147]
  ds_read_b64_tr_b16 v[68:69], v5 offset:128
  v_mfma_f32_16x16x32_bf16 v[148:151], v[56:59], v[16:19], v[148:151]
  ds_read_b64_tr_b16 v[70:71], v5 offset:1664
  v_mfma_f32_16x16x32_bf16 v[152:155], v[56:59], v[20:23], v[152:155]
  ds_read_b64_tr_b16 v[72:73], v6 offset:128
  v_mfma_f32_16x16x32_bf16 v[156:159], v[56:59], v[24:27], v[156:159]
  ds_read_b64_tr_b16 v[74:75], v6 offset:1664
  v_mfma_f32_16x16x32_bf16 v[160:163], v[60:63], v[12:15], v[160:163]
  ds_read_b64_tr_b16 v[76:77], v5 offset:256
  v_mfma_f32_16x16x32_bf16 v[164:167], v[60:63], v[16:19], v[164:167]
  ds_read_b64_tr_b16 v[78:79], v5 offset:1792
  v_mfma_f32_16x16x32_bf16 v[168:171], v[60:63], v[20:23], v[168:171]
  ds_read_b64_tr_b16 v[80:81], v6 offset:256
  v_mfma_f32_16x16x32_bf16 v[172:175], v[60:63], v[24:27], v[172:175]
  ds_read_b64_tr_b16 v[82:83], v6 offset:1792
  v_mfma_f32_16x16x32_bf16 v[176:179], v[64:67], v[12:15], v[176:179]
  ds_read_b128 v[84:87], v4
  v_mfma_f32_16x16x32_bf16 v[180:183], v[64:67], v[16:19], v[180:183]
  ds_read_b64_tr_b16 v[60:61], v5 offset:0
  v_mfma_f32_16x16x32_bf16 v[184:187], v[64:67], v[20:23], v[184:187]
  ds_read_b64_tr_b16 v[62:63], v5 offset:1536
  v_mfma_f32_16x16x32_bf16 v[188:191], v[64:67], v[24:27], v[188:191]
  s_waitcnt lgkmcnt(11)
  v_mfma_f32_16x16x32_bf16 v[96:99], v[44:47], v[28:31], v[96:99]
  ds_read_b64_tr_b16 v[64:65], v6 offset:0
  v_mfma_f32_16x16x32_bf16 v[100:103], v[44:47], v[32:35], v[100:103]
  ds_read_b64_tr_b16 v[66:67], v6 offset:1536
  v_mfma_f32_16x16x32_bf16 v[104:107], v[44:47], v[36:39], v[104:107]
  ds_read_b64_tr_b16 v[56:57], v8 offset:16448
  v_mfma_f32_16x16x32_bf16 v[108:111], v[44:47], v[40:43], v[108:111]
  ds_read_b64_tr_b16 v[58:59], v8 offset:16960
  v_mfma_f32_16x16x32_bf16 v[112:115], v[48:51], v[28:31], v[112:115]
  v_add_u32 v5, s79, v5
  v_mfma_f32_16x16x32_bf16 v[116:119], v[48:51], v[32:35], v[116:119]
  v_add_u32 v6, s79, v6
  v_mfma_f32_16x16x32_bf16 v[120:123], v[48:51], v[36:39], v[120:123]
  v_add_u32 v7, s79, v7
  v_mfma_f32_16x16x32_bf16 v[124:127], v[48:51], v[40:43], v[124:127]
  v_add_u32 v8, s79, v8
  v_mfma_f32_16x16x32_bf16 v[128:131], v[52:55], v[28:31], v[128:131]
  v_add_u32 v1, s73, v1
  v_mfma_f32_16x16x32_bf16 v[132:135], v[52:55], v[32:35], v[132:135]
  v_add_u32 v2, s73, v2
  v_mfma_f32_16x16x32_bf16 v[136:139], v[52:55], v[36:39], v[136:139]
  v_add_u32 v3, s73, v3
  v_mfma_f32_16x16x32_bf16 v[140:143], v[52:55], v[40:43], v[140:143]
  v_add_u32 v4, s73, v4
  s_waitcnt lgkmcnt(0)
  s_barrier
  v_mfma_f32_16x16x32_bf16 v[192:195], v[68:71], v[28:31], v[192:195]
  ds_read_b128 v[12:15], v1 offset:0
  v_mfma_f32_16x16x32_bf16 v[196:199], v[68:71], v[32:35], v[196:199]
  ds_read_b128 v[16:19], v1 offset:2048
  v_mfma_f32_16x16x32_bf16 v[200:203], v[68:71], v[36:39], v[200:203]
  ds_read_b128 v[20:23], v1 offset:4096
  v_mfma_f32_16x16x32_bf16 v[204:207], v[68:71], v[40:43], v[204:207]
  ds_read_b128 v[24:27], v1 offset:6144
  v_mfma_f32_16x16x32_bf16 v[208:211], v[72:75], v[28:31], v[208:211]
  ds_read_b64_tr_b16 v[44:45], v7 offset:12288
  v_mfma_f32_16x16x32_bf16 v[212:215], v[72:75], v[32:35], v[212:215]
  ds_read_b64_tr_b16 v[46:47], v7 offset:12800
  v_mfma_f32_16x16x32_bf16 v[216:219], v[72:75], v[36:39], v[216:219]
  ds_read_b64_tr_b16 v[48:49], v7 offset:16448
  v_mfma_f32_16x16x32_bf16 v[220:223], v[72:75], v[40:43], v[220:223]
  ds_read_b64_tr_b16 v[50:51], v7 offset:16960
  v_mfma_f32_16x16x32_bf16 v[224:227], v[28:31], v[76:79], v[224:227]
  ds_read_b64_tr_b16 v[52:53], v8 offset:12288
  v_mfma_f32_16x16x32_bf16 v[228:231], v[32:35], v[76:79], v[228:231]
  ds_read_b64_tr_b16 v[54:55], v8 offset:12800
  v_mfma_f32_16x16x32_bf16 v[232:235], v[36:39], v[76:79], v[232:235]
  s_xor_b32 s79, s79, s81
  v_mfma_f32_16x16x32_bf16 v[236:239], v[40:43], v[76:79], v[236:239]
  v_mfma_f32_16x16x32_bf16 v[240:243], v[28:31], v[80:83], v[240:243]
  v_mfma_f32_16x16x32_bf16 v[244:247], v[32:35], v[80:83], v[244:247]
  v_mfma_f32_16x16x32_bf16 v[248:251], v[36:39], v[80:83], v[248:251]
  v_mfma_f32_16x16x32_bf16 v[252:255], v[40:43], v[80:83], v[252:255]
  v_mfma_f32_16x16x32_bf16 v[88:91], v[68:71], v[84:87], v[88:91]
  v_mfma_f32_16x16x32_bf16 v[92:95], v[72:75], v[84:87], v[92:95]
  v_mfma_f32_16x16x32_bf16 v[144:147], v[56:59], v[28:31], v[144:147]
  ds_read_b64_tr_b16 v[68:69], v5 offset:128
  v_mfma_f32_16x16x32_bf16 v[148:151], v[56:59], v[32:35], v[148:151]
  ds_read_b64_tr_b16 v[70:71], v5 offset:1664
  v_mfma_f32_16x16x32_bf16 v[152:155], v[56:59], v[36:39], v[152:155]
  ds_read_b64_tr_b16 v[72:73], v6 offset:128
  v_mfma_f32_16x16x32_bf16 v[156:159], v[56:59], v[40:43], v[156:159]
  ds_read_b64_tr_b16 v[74:75], v6 offset:1664
  v_mfma_f32_16x16x32_bf16 v[160:163], v[60:63], v[28:31], v[160:163]
  ds_read_b64_tr_b16 v[76:77], v5 offset:256
  v_mfma_f32_16x16x32_bf16 v[164:167], v[60:63], v[32:35], v[164:167]
  ds_read_b64_tr_b16 v[78:79], v5 offset:1792
  v_mfma_f32_16x16x32_bf16 v[168:171], v[60:63], v[36:39], v[168:171]
  ds_read_b64_tr_b16 v[80:81], v6 offset:256
  v_mfma_f32_16x16x32_bf16 v[172:175], v[60:63], v[40:43], v[172:175]
  ds_read_b64_tr_b16 v[82:83], v6 offset:1792
  v_mfma_f32_16x16x32_bf16 v[176:179], v[64:67], v[28:31], v[176:179]
  ds_read_b128 v[84:87], v3
  v_mfma_f32_16x16x32_bf16 v[180:183], v[64:67], v[32:35], v[180:183]
  ds_read_b64_tr_b16 v[60:61], v5 offset:0
  v_mfma_f32_16x16x32_bf16 v[184:187], v[64:67], v[36:39], v[184:187]
  ds_read_b64_tr_b16 v[62:63], v5 offset:1536
  v_mfma_f32_16x16x32_bf16 v[188:191], v[64:67], v[40:43], v[188:191]
  s_add_u32 s69, s69, 2
  s_cmp_eq_u32 s69, 14
  s_cbranch_scc0 L_clP0
  s_branch L_cendP
L_clP1:
  s_waitcnt lgkmcnt(11)
  v_mfma_f32_16x16x32_bf16 v[96:99], v[44:47], v[12:15], v[96:99]
  ds_read_b64_tr_b16 v[64:65], v6 offset:0
  v_mfma_f32_16x16x32_bf16 v[100:103], v[44:47], v[16:19], v[100:103]
  ds_read_b64_tr_b16 v[66:67], v6 offset:1536
  v_mfma_f32_16x16x32_bf16 v[104:107], v[44:47], v[20:23], v[104:107]
  ds_read_b64_tr_b16 v[56:57], v8 offset:16448
  v_mfma_f32_16x16x32_bf16 v[108:111], v[44:47], v[24:27], v[108:111]
  ds_read_b64_tr_b16 v[58:59], v8 offset:16960
  v_mfma_f32_16x16x32_bf16 v[112:115], v[48:51], v[12:15], v[112:115]
  v_add_u32 v5, s80, v5
  v_mfma_f32_16x16x32_bf16 v[116:119], v[48:51], v[16:19], v[116:119]
  v_add_u32 v6, s80, v6
  v_mfma_f32_16x16x32_bf16 v[120:123], v[48:51], v[20:23], v[120:123]
  v_add_u32 v7, s80, v7
  v_mfma_f32_16x16x32_bf16 v[124:127], v[48:51], v[24:27], v[124:127]
  v_add_u32 v8, s80, v8
  v_mfma_f32_16x16x32_bf16 v[128:131], v[52:55], v[12:15], v[128:131]
  v_mfma_f32_16x16x32_bf16 v[132:135], v[52:55], v[16:19], v[132:135]
  v_mfma_f32_16x16x32_bf16 v[136:139], v[52:55], v[20:23], v[136:139]
  v_mfma_f32_16x16x32_bf16 v[140:143], v[52:55], v[24:27], v[140:143]
  s_waitcnt lgkmcnt(0)
  s_barrier
  v_mfma_f32_16x16x32_bf16 v[192:195], v[68:71], v[12:15], v[192:195]
  ds_read_b128 v[28:31], v2 offset:0
  v_mfma_f32_16x16x32_bf16 v[196:199], v[68:71], v[16:19], v[196:199]
  ds_read_b128 v[32:35], v2 offset:2048
  v_mfma_f32_16x16x32_bf16 v[200:203], v[68:71], v[20:23], v[200:203]
  ds_read_b128 v[36:39], v2 offset:4096
  v_mfma_f32_16x16x32_bf16 v[204:207], v[68:71], v[24:27], v[204:207]
  ds_read_b128 v[40:43], v2 offset:6144
  v_mfma_f32_16x16x32_bf16 v[208:211], v[72:75], v[12:15], v[208:211]
  ds_read_b64_tr_b16 v[44:45], v7 offset:12288
  v_mfma_f32_16x16x32_bf16 v[212:215], v[72:75], v[16:19], v[212:215]
  ds_read_b64_tr_b16 v[46:47], v7 offset:12800
  v_mfma_f32_16x16x32_bf16 v[216:219], v[72:75], v[20:23], v[216:219]
  ds_read_b64_tr_b16 v[48:49], v7 offset:16448
  v_mfma_f32_16x16x32_bf16 v[220:223], v[72:75], v[24:27], v[220:223]
  ds_read_b64_tr_b16 v[50:51], v7 offset:16960
  v_mfma_f32_16x16x32_bf16 v[224:227], v[12:15], v[76:79], v[224:227]
  ds_read_b64_tr_b16 v[52:53], v8 offset:12288
  v_mfma_f32_16x16x32_bf16 v[228:231], v[16:19], v[76:79], v[228:231]
  ds_read_b64_tr_b16 v[54:55], v8 offset:12800
  v_mfma_f32_16x16x32_bf16 v[232:235], v[20:23], v[76:79], v[232:235]
  s_add_u32 s72, s72, 1
  v_mfma_f32_16x16x32_bf16 v[236:239], v[24:27], v[76:79], v[236:239]
  s_cmp_eq_u32 s72, 3
  v_mfma_f32_16x16x32_bf16 v[240:243], v[12:15], v[80:83], v[240:243]
  s_cselect_b32 s73, s77, s76
  v_mfma_f32_16x16x32_bf16 v[244:247], v[16:19], v[80:83], v[244:247]
  s_cselect_b32 s72, 0, s72
  v_mfma_f32_16x16x32_bf16 v[248:251], v[20:23], v[80:83], v[248:251]
  v_mfma_f32_16x16x32_bf16 v[252:255], v[24:27], v[80:83], v[252:255]
  v_mfma_f32_16x16x32_bf16 v[88:91], v[84:87], v[76:79], v[88:91]
  v_mfma_f32_16x16x32_bf16 v[92:95], v[84:87], v[80:83], v[92:95]
  v_mfma_f32_16x16x32_bf16 v[144:147], v[56:59], v[12:15], v[144:147]
  ds_read_b64_tr_b16 v[68:69], v5 offset:128
  v_mfma_f32_16x16x32_bf16 v[148:151], v[56:59], v[16:19], v[148:151]
  ds_read_b64_tr_b16 v[70:71], v5 offset:1664
  v_mfma_f32_16x16x32_bf16 v[152:155], v[56:59], v[20:23], v[152:155]
  ds_read_b64_tr_b16 v[72:73], v6 offset:128
  v_mfma_f32_16x16x32_bf16 v[156:159], v[56:59], v[24:27], v[156:159]
  ds_read_b64_tr_b16 v[74:75], v6 offset:1664
  v_mfma_f32_16x16x32_bf16 v[160:163], v[60:63], v[12:15], v[160:163]
  ds_read_b64_tr_b16 v[76:77], v5 offset:256
  v_mfma_f32_16x16x32_bf16 v[164:167], v[60:63], v[16:19], v[164:167]
  ds_read_b64_tr_b16 v[78:79], v5 offset:1792
  v_mfma_f32_16x16x32_bf16 v[168:171], v[60:63], v[20:23], v[168:171]
  ds_read_b64_tr_b16 v[80:81], v6 offset:256
  v_mfma_f32_16x16x32_bf16 v[172:175], v[60:63], v[24:27], v[172:175]
  ds_read_b64_tr_b16 v[82:83], v6 offset:1792
  v_mfma_f32_16x16x32_bf16 v[176:179], v[64:67], v[12:15], v[176:179]
  ds_read_b128 v[84:87], v4
  v_mfma_f32_16x16x32_bf16 v[180:183], v[64:67], v[16:19], v[180:183]
  ds_read_b64_tr_b16 v[60:61], v5 offset:0
  v_mfma_f32_16x16x32_bf16 v[184:187], v[64:67], v[20:23], v[184:187]
  ds_read_b64_tr_b16 v[62:63], v5 offset:1536
  v_mfma_f32_16x16x32_bf16 v[188:191], v[64:67], v[24:27], v[188:191]
  s_waitcnt lgkmcnt(11)
  v_mfma_f32_16x16x32_bf16 v[96:99], v[44:47], v[28:31], v[96:99]
  ds_read_b64_tr_b16 v[64:65], v6 offset:0
  v_mfma_f32_16x16x32_bf16 v[100:103], v[44:47], v[32:35], v[100:103]
  ds_read_b64_tr_b16 v[66:67], v6 offset:1536
  v_mfma_f32_16x16x32_bf16 v[104:107], v[44:47], v[36:39], v[104:107]
  ds_read_b64_tr_b16 v[56:57], v8 offset:16448
  v_mfma_f32_16x16x32_bf16 v[108:111], v[44:47], v[40:43], v[108:111]
  ds_read_b64_tr_b16 v[58:59], v8 offset:16960
  v_mfma_f32_16x16x32_bf16 v[112:115], v[48:51], v[28:31], v[112:115]
  v_add_u32 v5, s79, v5
  v_mfma_f32_16x16x32_bf16 v[116:119], v[48:51], v[32:35], v[116:119]
  v_add_u32 v6, s79, v6
  v_mfma_f32_16x16x32_bf16 v[120:123], v[48:51], v[36:39], v[120:123]
  v_add_u32 v7, s79, v7
  v_mfma_f32_16x16x32_bf16 v[124:127], v[48:51], v[40:43], v[124:127]
  v_add_u32 v8, s79, v8
  v_mfma_f32_16x16x32_bf16 v[128:131], v[52:55], v[28:31], v[128:131]
  v_add_u32 v1, s73, v1
  v_mfma_f32_16x16x32_bf16 v[132:135], v[52:55], v[32:35], v[132:135]
  v_add_u32 v2, s73, v2
  v_mfma_f32_16x16x32_bf16 v[136:139], v[52:55], v[36:39], v[136:139]
  v_add_u32 v3, s73, v3
  v_mfma_f32_16x16x32_bf16 v[140:143], v[52:55], v[40:43], v[140:143]
  v_add_u32 v4, s73, v4
  s_waitcnt lgkmcnt(0)
  s_barrier
  v_mfma_f32_16x16x32_bf16 v[192:195], v[68:71], v[28:31], v[192:195]
  ds_read_b128 v[12:15], v1 offset:0
  v_mfma_f32_16x16x32_bf16 v[196:199], v[68:71], v[32:35], v[196:199]
  ds_read_b128 v[16:19], v1 offset:2048
  v_mfma_f32_16x16x32_bf16 v[200:203], v[68:71], v[36:39], v[200:203]
  ds_read_b128 v[20:23], v1 offset:4096
  v_mfma_f32_16x16x32_bf16 v[204:207], v[68:71], v[40:43], v[204:207]
  ds_read_b128 v[24:27], v1 offset:6144
  v_mfma_f32_16x16x32_bf16 v[208:211], v[72:75], v[28:31], v[208:211]
  ds_read_b64_tr_b16 v[44:45], v7 offset:12288
  v_mfma_f32_16x16x32_bf16 v[212:215], v[72:75], v[32:35], v[212:215]
  ds_read_b64_tr_b16 v[46:47], v7 offset:12800
  v_mfma_f32_16x16x32_bf16 v[216:219], v[72:75], v[36:39], v[216:219]
  ds_read_b64_tr_b16 v[48:49], v7 offset:16448
  v_mfma_f32_16x16x32_bf16 v[220:223], v[72:75], v[40:43], v[220:223]
  ds_read_b64_tr_b16 v[50:51], v7 offset:16960
  v_mfma_f32_16x16x32_bf16 v[224:227], v[28:31], v[76:79], v[224:227]
  ds_read_b64_tr_b16 v[52:53], v8 offset:12288
  v_mfma_f32_16x16x32_bf16 v[228:231], v[32:35], v[76:79], v[228:231]
  ds_read_b64_tr_b16 v[54:55], v8 offset:12800
  v_mfma_f32_16x16x32_bf16 v[232:235], v[36:39], v[76:79], v[232:235]
  s_xor_b32 s79, s79, s81
  v_mfma_f32_16x16x32_bf16 v[236:239], v[40:43], v[76:79], v[236:239]
  v_mfma_f32_16x16x32_bf16 v[240:243], v[28:31], v[80:83], v[240:243]
  v_mfma_f32_16x16x32_bf16 v[244:247], v[32:35], v[80:83], v[244:247]
  v_mfma_f32_16x16x32_bf16 v[248:251], v[36:39], v[80:83], v[248:251]
  v_mfma_f32_16x16x32_bf16 v[252:255], v[40:43], v[80:83], v[252:255]
  v_mfma_f32_16x16x32_bf16 v[88:91], v[84:87], v[76:79], v[88:91]
  v_mfma_f32_16x16x32_bf16 v[92:95], v[84:87], v[80:83], v[92:95]
  v_mfma_f32_16x16x32_bf16 v[144:147], v[56:59], v[28:31], v[144:147]
  ds_read_b64_tr_b16 v[68:69], v5 offset:128
  v_mfma_f32_16x16x32_bf16 v[148:151], v[56:59], v[32:35], v[148:151]
  ds_read_b64_tr_b16 v[70:71], v5 offset:1664
  v_mfma_f32_16x16x32_bf16 v[152:155], v[56:59], v[36:39], v[152:155]
  ds_read_b64_tr_b16 v[72:73], v6 offset:128
  v_mfma_f32_16x16x32_bf16 v[156:159], v[56:59], v[40:43], v[156:159]
  ds_read_b64_tr_b16 v[74:75], v6 offset:1664
  v_mfma_f32_16x16x32_bf16 v[160:163], v[60:63], v[28:31], v[160:163]
  ds_read_b64_tr_b16 v[76:77], v5 offset:256
  v_mfma_f32_16x16x32_bf16 v[164:167], v[60:63], v[32:35], v[164:167]
  ds_read_b64_tr_b16 v[78:79], v5 offset:1792
  v_mfma_f32_16x16x32_bf16 v[168:171], v[60:63], v[36:39], v[168:171]
  ds_read_b64_tr_b16 v[80:81], v6 offset:256
  v_mfma_f32_16x16x32_bf16 v[172:175], v[60:63], v[40:43], v[172:175]
  ds_read_b64_tr_b16 v[82:83], v6 offset:1792
  v_mfma_f32_16x16x32_bf16 v[176:179], v[64:67], v[28:31], v[176:179]
  ds_read_b128 v[84:87], v3
  v_mfma_f32_16x16x32_bf16 v[180:183], v[64:67], v[32:35], v[180:183]
  ds_read_b64_tr_b16 v[60:61], v5 offset:0
  v_mfma_f32_16x16x32_bf16 v[184:187], v[64:67], v[36:39], v[184:187]
  ds_read_b64_tr_b16 v[62:63], v5 offset:1536
  v_mfma_f32_16x16x32_bf16 v[188:191], v[64:67], v[40:43], v[188:191]
  s_add_u32 s69, s69, 2
  s_cmp_eq_u32 s69, 14
  s_cbranch_scc0 L_clP1
L_cendP:
  s_waitcnt lgkmcnt(0)
  s_barrier
HOP20:
  s_cbranch_execz HOP36
  v_mov_b32 v1, 152960
  ds_read_b32 v1, v1
  v_and_b32 v12, 15, v0
  s_lshl_b32 s53, s70, 6
  s_add_u32 s53, s53, 16
  v_add_u32 v12, s53, v12
  v_lshlrev_b32 v12, 2, v12
  v_add_u32 v12, 150528, v12
  ds_read_b32 v2, v12 offset:0
  ds_read_b32 v6, v12 offset:576
  ds_read_b32 v3, v12 offset:64
  ds_read_b32 v7, v12 offset:640
  ds_read_b32 v4, v12 offset:128
  ds_read_b32 v8, v12 offset:704
  ds_read_b32 v5, v12 offset:192
  ds_read_b32 v9, v12 offset:768
  v_lshrrev_b32 v10, 4, v0
  v_lshlrev_b32 v10, 4, v10
  s_mul_i32 s53, s71, 640
  s_add_u32 s53, s53, 151680
  v_add_u32 v10, s53, v10
  v_lshlrev_b32 v11, 4, v0
  ds_read_b128 v[16:19], v10 offset:256
  ds_read_b128 v[20:23], v10 offset:320
  ds_read_b128 v[24:27], v10 offset:384
  ds_read_b128 v[28:31], v10 offset:448
  v_and_b32 v12, 15, v0
  v_lshlrev_b32 v12, 2, v12
  s_mul_i32 s53, s71, 640
  s_add_u32 s53, s53, 152192
  v_add_u32 v12, s53, v12
  ds_read_b32 v32, v12
  ds_read_b32 v33, v12 offset:64
  v_lshrrev_b32 v13, 4, v0
  v_lshlrev_b32 v13, 4, v13
  s_lshl_b32 s53, s70, 8
  s_add_u32 s53, s53, 150592
  v_add_u32 v13, s53, v13
HOP21:
  s_cbranch_execz HOP37
  ds_read_b128 v[36:39], v13 offset:0
  ds_read_b128 v[52:55], v13 offset:576
  ds_read_b128 v[40:43], v13 offset:64
  ds_read_b128 v[56:59], v13 offset:640
  ds_read_b128 v[44:47], v13 offset:128
  ds_read_b128 v[60:63], v13 offset:704
  ds_read_b128 v[48:51], v13 offset:192
  ds_read_b128 v[64:67], v13 offset:768
  s_lshl_b32 s53, s71, 3
  s_lshl_b32 s54, s70, 2
  s_add_u32 s53, s53, s54
  s_lshl_b32 s53, s53, 10
  v_add_u32 v14, s53, v11
  s_mul_i32 s53, s71, 9
  s_add_u32 s53, s53, s54
  s_add_u32 s53, s53, 1
  s_lshl_b32 s53, s53, 10
  v_add_u32 v15, s53, v11
  v_lshlrev_b32 v68, 3, v0
  v_add_u32 v68, s53, v68
  v_cmp_gt_u32 vcc, 48, v0
  s_waitcnt lgkmcnt(10)
  v_readfirstlane_b32 s67, v1
  v_pk_fma_f32 v[160:161], v[2:3], v[16:17], v[160:161] op_sel:[0,0,0] op_sel_hi:[0,1,1] neg_lo:[1,0,0] neg_hi:[1,0,0]
  v_pk_fma_f32 v[162:163], v[2:3], v[18:19], v[162:163] op_sel:[0,0,0] op_sel_hi:[0,1,1] neg_lo:[1,0,0] neg_hi:[1,0,0]
  v_pk_fma_f32 v[176:177], v[2:3], v[20:21], v[176:177] op_sel:[0,0,0] op_sel_hi:[0,1,1] neg_lo:[1,0,0] neg_hi:[1,0,0]
  v_pk_fma_f32 v[178:179], v[2:3], v[22:23], v[178:179] op_sel:[0,0,0] op_sel_hi:[0,1,1] neg_lo:[1,0,0] neg_hi:[1,0,0]
  v_cvt_pk_bf16_f32 v160, v160, v161
  v_cvt_pk_bf16_f32 v161, v162, v163
  v_cvt_pk_bf16_f32 v162, v176, v177
  v_cvt_pk_bf16_f32 v163, v178, v179
  v_cndmask_b32 v162, 0, v162, vcc
  v_cndmask_b32 v163, 0, v163, vcc
  ds_write_b128 v14, v[160:163] offset:36864
  v_pk_fma_f32 v[192:193], v[2:3], v[24:25], v[192:193] op_sel:[0,0,0] op_sel_hi:[0,1,1] neg_lo:[1,0,0] neg_hi:[1,0,0]
  v_pk_fma_f32 v[194:195], v[2:3], v[26:27], v[194:195] op_sel:[0,0,0] op_sel_hi:[0,1,1] neg_lo:[1,0,0] neg_hi:[1,0,0]
  v_pk_fma_f32 v[208:209], v[2:3], v[28:29], v[208:209] op_sel:[0,0,0] op_sel_hi:[0,1,1] neg_lo:[1,0,0] neg_hi:[1,0,0]
  v_pk_fma_f32 v[210:211], v[2:3], v[30:31], v[210:211] op_sel:[0,0,0] op_sel_hi:[0,1,1] neg_lo:[1,0,0] neg_hi:[1,0,0]
  v_pk_mul_f32 v[192:193], v[6:7], v[192:193] op_sel:[0,0] op_sel_hi:[0,1]
HOP22:
  s_cbranch_execz HOP38
  v_pk_mul_f32 v[194:195], v[6:7], v[194:195] op_sel:[0,0] op_sel_hi:[0,1]
  v_pk_mul_f32 v[208:209], v[6:7], v[208:209] op_sel:[0,0] op_sel_hi:[0,1]
  v_pk_mul_f32 v[210:211], v[6:7], v[210:211] op_sel:[0,0] op_sel_hi:[0,1]
  v_cvt_pk_bf16_f32 v192, v192, v193
  v_cvt_pk_bf16_f32 v193, v194, v195
  v_cvt_pk_bf16_f32 v194, v208, v209
  v_cvt_pk_bf16_f32 v195, v210, v211
  ds_write_b128 v15, v[192:195] offset:0
  v_pk_fma_f32 v[164:165], v[2:3], v[16:17], v[164:165] op_sel:[1,0,0] op_sel_hi:[1,1,1] neg_lo:[1,0,0] neg_hi:[1,0,0]
  v_pk_fma_f32 v[166:167], v[2:3], v[18:19], v[166:167] op_sel:[1,0,0] op_sel_hi:[1,1,1] neg_lo:[1,0,0] neg_hi:[1,0,0]
  v_pk_fma_f32 v[180:181], v[2:3], v[20:21], v[180:181] op_sel:[1,0,0] op_sel_hi:[1,1,1] neg_lo:[1,0,0] neg_hi:[1,0,0]
  v_pk_fma_f32 v[182:183], v[2:3], v[22:23], v[182:183] op_sel:[1,0,0] op_sel_hi:[1,1,1] neg_lo:[1,0,0] neg_hi:[1,0,0]
  v_cvt_pk_bf16_f32 v164, v164, v165
  v_cvt_pk_bf16_f32 v165, v166, v167
  v_cvt_pk_bf16_f32 v166, v180, v181
  v_cvt_pk_bf16_f32 v167, v182, v183
  v_cndmask_b32 v166, 0, v166, vcc
  v_cndmask_b32 v167, 0, v167, vcc
  ds_write_b128 v14, v[164:167] offset:37888
  v_pk_fma_f32 v[196:197], v[2:3], v[24:25], v[196:197] op_sel:[1,0,0] op_sel_hi:[1,1,1] neg_lo:[1,0,0] neg_hi:[1,0,0]
  v_pk_fma_f32 v[198:199], v[2:3], v[26:27], v[198:199] op_sel:[1,0,0] op_sel_hi:[1,1,1] neg_lo:[1,0,0] neg_hi:[1,0,0]
  v_pk_fma_f32 v[212:213], v[2:3], v[28:29], v[212:213] op_sel:[1,0,0] op_sel_hi:[1,1,1] neg_lo:[1,0,0] neg_hi:[1,0,0]
  v_pk_fma_f32 v[214:215], v[2:3], v[30:31], v[214:215] op_sel:[1,0,0] op_sel_hi:[1,1,1] neg_lo:[1,0,0] neg_hi:[1,0,0]
  v_pk_mul_f32 v[196:197], v[6:7], v[196:197] op_sel:[1,0] op_sel_hi:[1,1]
  v_pk_mul_f32 v[198:199], v[6:7], v[198:199] op_sel:[1,0] op_sel_hi:[1,1]
  v_pk_mul_f32 v[212:213], v[6:7], v[212:213] op_sel:[1,0] op_sel_hi:[1,1]
  v_pk_mul_f32 v[214:215], v[6:7], v[214:215] op_sel:[1,0] op_sel_hi:[1,1]
  v_cvt_pk_bf16_f32 v196, v196, v197
  v_cvt_pk_bf16_f32 v197, v198, v199
  v_cvt_pk_bf16_f32 v198, v212, v213
  v_cvt_pk_bf16_f32 v199, v214, v215
HOP23:
  s_cbranch_execz HOP39
  ds_write_b128 v15, v[196:199] offset:1024
  v_pk_fma_f32 v[168:169], v[4:5], v[16:17], v[168:169] op_sel:[0,0,0] op_sel_hi:[0,1,1] neg_lo:[1,0,0] neg_hi:[1,0,0]
  v_pk_fma_f32 v[170:171], v[4:5], v[18:19], v[170:171] op_sel:[0,0,0] op_sel_hi:[0,1,1] neg_lo:[1,0,0] neg_hi:[1,0,0]
  v_pk_fma_f32 v[184:185], v[4:5], v[20:21], v[184:185] op_sel:[0,0,0] op_sel_hi:[0,1,1] neg_lo:[1,0,0] neg_hi:[1,0,0]
  v_pk_fma_f32 v[186:187], v[4:5], v[22:23], v[186:187] op_sel:[0,0,0] op_sel_hi:[0,1,1] neg_lo:[1,0,0] neg_hi:[1,0,0]
  v_cvt_pk_bf16_f32 v168, v168, v169
  v_cvt_pk_bf16_f32 v169, v170, v171
  v_cvt_pk_bf16_f32 v170, v184, v185
  v_cvt_pk_bf16_f32 v171, v186, v187
  v_cndmask_b32 v170, 0, v170, vcc
  v_cndmask_b32 v171, 0, v171, vcc
  ds_write_b128 v14, v[168:171] offset:38912
  v_pk_fma_f32 v[200:201], v[4:5], v[24:25], v[200:201] op_sel:[0,0,0] op_sel_hi:[0,1,1] neg_lo:[1,0,0] neg_hi:[1,0,0]
  v_pk_fma_f32 v[202:203], v[4:5], v[26:27], v[202:203] op_sel:[0,0,0] op_sel_hi:[0,1,1] neg_lo:[1,0,0] neg_hi:[1,0,0]
  v_pk_fma_f32 v[216:217], v[4:5], v[28:29], v[216:217] op_sel:[0,0,0] op_sel_hi:[0,1,1] neg_lo:[1,0,0] neg_hi:[1,0,0]
  v_pk_fma_f32 v[218:219], v[4:5], v[30:31], v[218:219] op_sel:[0,0,0] op_sel_hi:[0,1,1] neg_lo:[1,0,0] neg_hi:[1,0,0]
  v_pk_mul_f32 v[200:201], v[8:9], v[200:201] op_sel:[0,0] op_sel_hi:[0,1]
  v_pk_mul_f32 v[202:203], v[8:9], v[202:203] op_sel:[0,0] op_sel_hi:[0,1]
  v_pk_mul_f32 v[216:217], v[8:9], v[216:217] op_sel:[0,0] op_sel_hi:[0,1]
  v_pk_mul_f32 v[218:219], v[8:9], v[218:219] op_sel:[0,0] op_sel_hi:[0,1]
  v_cvt_pk_bf16_f32 v200, v200, v201
  v_cvt_pk_bf16_f32 v201, v202, v203
  v_cvt_pk_bf16_f32 v202, v216, v217
  v_cvt_pk_bf16_f32 v203, v218, v219
  ds_write_b128 v15, v[200:203] offset:2048
  v_pk_fma_f32 v[172:173], v[4:5], v[16:17], v[172:173] op_sel:[1,0,0] op_sel_hi:[1,1,1] neg_lo:[1,0,0] neg_hi:[1,0,0]
  v_pk_fma_f32 v[174:175], v[4:5], v[18:19], v[174:175] op_sel:[1,0,0] op_sel_hi:[1,1,1] neg_lo:[1,0,0] neg_hi:[1,0,0]
  v_pk_fma_f32 v[188:189], v[4:5], v[20:21], v[188:189] op_sel:[1,0,0] op_sel_hi:[1,1,1] neg_lo:[1,0,0] neg_hi:[1,0,0]
  v_pk_fma_f32 v[190:191], v[4:5], v[22:23], v[190:191] op_sel:[1,0,0] op_sel_hi:[1,1,1] neg_lo:[1,0,0] neg_hi:[1,0,0]
  v_cvt_pk_bf16_f32 v172, v172, v173
  v_cvt_pk_bf16_f32 v173, v174, v175
HOP24:
  s_cbranch_execz HOP40
  v_cvt_pk_bf16_f32 v174, v188, v189
  v_cvt_pk_bf16_f32 v175, v190, v191
  v_cndmask_b32 v174, 0, v174, vcc
  v_cndmask_b32 v175, 0, v175, vcc
  ds_write_b128 v14, v[172:175] offset:39936
  v_pk_fma_f32 v[204:205], v[4:5], v[24:25], v[204:205] op_sel:[1,0,0] op_sel_hi:[1,1,1] neg_lo:[1,0,0] neg_hi:[1,0,0]
  v_pk_fma_f32 v[206:207], v[4:5], v[26:27], v[206:207] op_sel:[1,0,0] op_sel_hi:[1,1,1] neg_lo:[1,0,0] neg_hi:[1,0,0]
  v_pk_fma_f32 v[220:221], v[4:5], v[28:29], v[220:221] op_sel:[1,0,0] op_sel_hi:[1,1,1] neg_lo:[1,0,0] neg_hi:[1,0,0]
  v_pk_fma_f32 v[222:223], v[4:5], v[30:31], v[222:223] op_sel:[1,0,0] op_sel_hi:[1,1,1] neg_lo:[1,0,0] neg_hi:[1,0,0]
  v_pk_mul_f32 v[204:205], v[8:9], v[204:205] op_sel:[1,0] op_sel_hi:[1,1]
  v_pk_mul_f32 v[206:207], v[8:9], v[206:207] op_sel:[1,0] op_sel_hi:[1,1]
  v_pk_mul_f32 v[220:221], v[8:9], v[220:221] op_sel:[1,0] op_sel_hi:[1,1]
  v_pk_mul_f32 v[222:223], v[8:9], v[222:223] op_sel:[1,0] op_sel_hi:[1,1]
  v_cvt_pk_bf16_f32 v204, v204, v205
  v_cvt_pk_bf16_f32 v205, v206, v207
  v_cvt_pk_bf16_f32 v206, v220, v221
  v_cvt_pk_bf16_f32 v207, v222, v223
  ds_write_b128 v15, v[204:207] offset:3072
  s_waitcnt lgkmcnt(8)
  v_pk_fma_f32 v[224:225], v[36:37], v[32:33], v[224:225] op_sel:[0,0,0] op_sel_hi:[1,0,1] neg_lo:[1,0,0] neg_hi:[1,0,0]
  v_pk_fma_f32 v[226:227], v[38:39], v[32:33], v[226:227] op_sel:[0,0,0] op_sel_hi:[1,0,1] neg_lo:[1,0,0] neg_hi:[1,0,0]
  v_pk_mul_f32 v[224:225], v[52:53], v[224:225]
  v_pk_mul_f32 v[226:227], v[54:55], v[226:227]
  v_cvt_pk_bf16_f32 v224, v224, v225
  v_cvt_pk_bf16_f32 v225, v226, v227
  ds_write_b64 v68, v[224:225] offset:18432
  v_pk_fma_f32 v[240:241], v[36:37], v[32:33], v[240:241] op_sel:[0,1,0] op_sel_hi:[1,1,1] neg_lo:[1,0,0] neg_hi:[1,0,0]
  v_pk_fma_f32 v[242:243], v[38:39], v[32:33], v[242:243] op_sel:[0,1,0] op_sel_hi:[1,1,1] neg_lo:[1,0,0] neg_hi:[1,0,0]
  v_pk_mul_f32 v[240:241], v[52:53], v[240:241]
  v_pk_mul_f32 v[242:243], v[54:55], v[242:243]
  v_cvt_pk_bf16_f32 v240, v240, v241
  v_cvt_pk_bf16_f32 v241, v242, v243
HOP25:
  s_cbranch_execz HOP41
  ds_write_b64 v68, v[240:241] offset:18944
  v_pk_fma_f32 v[228:229], v[40:41], v[32:33], v[228:229] op_sel:[0,0,0] op_sel_hi:[1,0,1] neg_lo:[1,0,0] neg_hi:[1,0,0]
  v_pk_fma_f32 v[230:231], v[42:43], v[32:33], v[230:231] op_sel:[0,0,0] op_sel_hi:[1,0,1] neg_lo:[1,0,0] neg_hi:[1,0,0]
  v_pk_mul_f32 v[228:229], v[56:57], v[228:229]
  v_pk_mul_f32 v[230:231], v[58:59], v[230:231]
  v_cvt_pk_bf16_f32 v228, v228, v229
  v_cvt_pk_bf16_f32 v229, v230, v231
  ds_write_b64 v68, v[228:229] offset:19456
  v_pk_fma_f32 v[244:245], v[40:41], v[32:33], v[244:245] op_sel:[0,1,0] op_sel_hi:[1,1,1] neg_lo:[1,0,0] neg_hi:[1,0,0]
  v_pk_fma_f32 v[246:247], v[42:43], v[32:33], v[246:247] op_sel:[0,1,0] op_sel_hi:[1,1,1] neg_lo:[1,0,0] neg_hi:[1,0,0]
  v_pk_mul_f32 v[244:245], v[56:57], v[244:245]
  v_pk_mul_f32 v[246:247], v[58:59], v[246:247]
  v_cvt_pk_bf16_f32 v244, v244, v245
  v_cvt_pk_bf16_f32 v245, v246, v247
  ds_write_b64 v68, v[244:245] offset:19968
  v_pk_fma_f32 v[232:233], v[44:45], v[32:33], v[232:233] op_sel:[0,0,0] op_sel_hi:[1,0,1] neg_lo:[1,0,0] neg_hi:[1,0,0]
  v_pk_fma_f32 v[234:235], v[46:47], v[32:33], v[234:235] op_sel:[0,0,0] op_sel_hi:[1,0,1] neg_lo:[1,0,0] neg_hi:[1,0,0]
  v_pk_mul_f32 v[232:233], v[60:61], v[232:233]
  v_pk_mul_f32 v[234:235], v[62:63], v[234:235]
  v_cvt_pk_bf16_f32 v232, v232, v233
  v_cvt_pk_bf16_f32 v233, v234, v235
  ds_write_b64 v68, v[232:233] offset:20480
  v_pk_fma_f32 v[248:249], v[44:45], v[32:33], v[248:249] op_sel:[0,1,0] op_sel_hi:[1,1,1] neg_lo:[1,0,0] neg_hi:[1,0,0]
  v_pk_fma_f32 v[250:251], v[46:47], v[32:33], v[250:251] op_sel:[0,1,0] op_sel_hi:[1,1,1] neg_lo:[1,0,0] neg_hi:[1,0,0]
  v_pk_mul_f32 v[248:249], v[60:61], v[248:249]
  v_pk_mul_f32 v[250:251], v[62:63], v[250:251]
  v_cvt_pk_bf16_f32 v248, v248, v249
  v_cvt_pk_bf16_f32 v249, v250, v251
  ds_write_b64 v68, v[248:249] offset:20992
  v_pk_fma_f32 v[236:237], v[48:49], v[32:33], v[236:237] op_sel:[0,0,0] op_sel_hi:[1,0,1] neg_lo:[1,0,0] neg_hi:[1,0,0]
HOP26:
  s_cbranch_execz HOP42
  v_pk_fma_f32 v[238:239], v[50:51], v[32:33], v[238:239] op_sel:[0,0,0] op_sel_hi:[1,0,1] neg_lo:[1,0,0] neg_hi:[1,0,0]
  v_pk_mul_f32 v[236:237], v[64:65], v[236:237]
  v_pk_mul_f32 v[238:239], v[66:67], v[238:239]
  v_cvt_pk_bf16_f32 v236, v236, v237
  v_cvt_pk_bf16_f32 v237, v238, v239
  ds_write_b64 v68, v[236:237] offset:21504
  v_pk_fma_f32 v[252:253], v[48:49], v[32:33], v[252:253] op_sel:[0,1,0] op_sel_hi:[1,1,1] neg_lo:[1,0,0] neg_hi:[1,0,0]
  v_pk_fma_f32 v[254:255], v[50:51], v[32:33], v[254:255] op_sel:[0,1,0] op_sel_hi:[1,1,1] neg_lo:[1,0,0] neg_hi:[1,0,0]
  v_pk_mul_f32 v[252:253], v[64:65], v[252:253]
  v_pk_mul_f32 v[254:255], v[66:67], v[254:255]
  v_cvt_pk_bf16_f32 v252, v252, v253
  v_cvt_pk_bf16_f32 v253, v254, v255
  ds_write_b64 v68, v[252:253] offset:22016
  s_mul_i32 s53, s71, 9216
  s_cmp_eq_u32 s70, 0
  s_cbranch_scc0 L_haloV
  v_and_b32 v12, 15, v0
  v_lshlrev_b32 v12, 2, v12
  v_add_u32 v12, 150528, v12
  ds_read_b32 v34, v12
  ds_read_b32 v35, v12 offset:576
  v_add_u32 v12, s53, v11
  s_waitcnt lgkmcnt(0)
  v_pk_fma_f32 v[88:89], v[34:35], v[24:25], v[88:89] op_sel:[0,0,0] op_sel_hi:[0,1,1] neg_lo:[1,0,0] neg_hi:[1,0,0]
  v_pk_fma_f32 v[90:91], v[34:35], v[26:27], v[90:91] op_sel:[0,0,0] op_sel_hi:[0,1,1] neg_lo:[1,0,0] neg_hi:[1,0,0]
  v_pk_fma_f32 v[92:93], v[34:35], v[28:29], v[92:93] op_sel:[0,0,0] op_sel_hi:[0,1,1] neg_lo:[1,0,0] neg_hi:[1,0,0]
  v_pk_fma_f32 v[94:95], v[34:35], v[30:31], v[94:95] op_sel:[0,0,0] op_sel_hi:[0,1,1] neg_lo:[1,0,0] neg_hi:[1,0,0]
  v_pk_mul_f32 v[88:89], v[34:35], v[88:89] op_sel:[1,0] op_sel_hi:[1,1]
  v_pk_mul_f32 v[90:91], v[34:35], v[90:91] op_sel:[1,0] op_sel_hi:[1,1]
  v_pk_mul_f32 v[92:93], v[34:35], v[92:93] op_sel:[1,0] op_sel_hi:[1,1]
  v_pk_mul_f32 v[94:95], v[34:35], v[94:95] op_sel:[1,0] op_sel_hi:[1,1]
  v_cvt_pk_bf16_f32 v88, v88, v89
  v_cvt_pk_bf16_f32 v89, v90, v91
HOP27:
  s_cbranch_execz HOP43
  v_cvt_pk_bf16_f32 v90, v92, v93
  v_cvt_pk_bf16_f32 v91, v94, v95
  ds_write_b128 v12, v[88:91] offset:0
  s_branch L_haloD
L_haloV:
  v_lshrrev_b32 v12, 4, v0
  v_lshlrev_b32 v12, 4, v12
  v_add_u32 v12, 150528, v12
  ds_read_b128 v[36:39], v12
  ds_read_b128 v[52:55], v12 offset:576
  v_lshlrev_b32 v12, 3, v0
  v_add_u32 v12, s53, v12
  s_waitcnt lgkmcnt(0)
  v_pk_fma_f32 v[88:89], v[36:37], v[32:33], v[88:89] op_sel:[0,0,0] op_sel_hi:[1,0,1] neg_lo:[1,0,0] neg_hi:[1,0,0]
  v_pk_fma_f32 v[90:91], v[38:39], v[32:33], v[90:91] op_sel:[0,0,0] op_sel_hi:[1,0,1] neg_lo:[1,0,0] neg_hi:[1,0,0]
  v_pk_mul_f32 v[88:89], v[52:53], v[88:89]
  v_pk_mul_f32 v[90:91], v[54:55], v[90:91]
  v_cvt_pk_bf16_f32 v88, v88, v89
  v_cvt_pk_bf16_f32 v89, v90, v91
  ds_write_b64 v12, v[88:89] offset:18432
  v_pk_fma_f32 v[92:93], v[36:37], v[32:33], v[92:93] op_sel:[0,1,0] op_sel_hi:[1,1,1] neg_lo:[1,0,0] neg_hi:[1,0,0]
  v_pk_fma_f32 v[94:95], v[38:39], v[32:33], v[94:95] op_sel:[0,1,0] op_sel_hi:[1,1,1] neg_lo:[1,0,0] neg_hi:[1,0,0]
  v_pk_mul_f32 v[92:93], v[52:53], v[92:93]
  v_pk_mul_f32 v[94:95], v[54:55], v[94:95]
  v_cvt_pk_bf16_f32 v92, v92, v93
  v_cvt_pk_bf16_f32 v93, v94, v95
  ds_write_b64 v12, v[92:93] offset:18944
L_haloD:
  s_waitcnt lgkmcnt(0)
  s_barrier
  s_cmp_lt_u32 s66, 28
  s_cbranch_scc0 L_pe1
  v_lshlrev_b32 v15, 4, v0
  s_mul_i32 s53, s65, 72
  s_mul_i32 s54, s61, 5
  s_add_u32 s54, s54, 32
  s_add_u32 s54, s54, s53
  s_lshl_b32 s54, s54, 12
  s_add_u32 s80, s54, 9437184
  s_lshl_b32 s54, s61, 1
HOP28:
  s_cbranch_execz HOP44
  s_add_u32 s54, s54, s53
  s_lshl_b32 s54, s54, 12
  s_add_u32 s81, s54, 9437184
  s_add_u32 s56, s80, 0
  buffer_load_dwordx4 v[176:179], v15, s[40:43], s56 offen offset:0 sc1
  buffer_load_dwordx4 v[180:183], v15, s[40:43], s56 offen offset:1024 sc1
  buffer_load_dwordx4 v[184:187], v15, s[40:43], s56 offen offset:2048 sc1
  buffer_load_dwordx4 v[188:191], v15, s[40:43], s56 offen offset:3072 sc1
  s_add_u32 s56, s80, 4096
  buffer_load_dwordx4 v[192:195], v15, s[40:43], s56 offen offset:0 sc1
  buffer_load_dwordx4 v[196:199], v15, s[40:43], s56 offen offset:1024 sc1
  buffer_load_dwordx4 v[200:203], v15, s[40:43], s56 offen offset:2048 sc1
  buffer_load_dwordx4 v[204:207], v15, s[40:43], s56 offen offset:3072 sc1
  s_add_u32 s56, s80, 8192
  buffer_load_dwordx4 v[208:211], v15, s[40:43], s56 offen offset:0 sc1
  buffer_load_dwordx4 v[212:215], v15, s[40:43], s56 offen offset:1024 sc1
  buffer_load_dwordx4 v[216:219], v15, s[40:43], s56 offen offset:2048 sc1
  buffer_load_dwordx4 v[220:223], v15, s[40:43], s56 offen offset:3072 sc1
  s_add_u32 s56, s80, 12288
  buffer_load_dwordx4 v[224:227], v15, s[40:43], s56 offen offset:0 sc1
  buffer_load_dwordx4 v[228:231], v15, s[40:43], s56 offen offset:1024 sc1
  buffer_load_dwordx4 v[232:235], v15, s[40:43], s56 offen offset:2048 sc1
  buffer_load_dwordx4 v[236:239], v15, s[40:43], s56 offen offset:3072 sc1
  s_add_u32 s56, s80, 16384
  buffer_load_dwordx4 v[240:243], v15, s[40:43], s56 offen offset:0 sc1
  buffer_load_dwordx4 v[244:247], v15, s[40:43], s56 offen offset:1024 sc1
  buffer_load_dwordx4 v[248:251], v15, s[40:43], s56 offen offset:2048 sc1
  buffer_load_dwordx4 v[252:255], v15, s[40:43], s56 offen offset:3072 sc1
L_pe1:
  ds_read_b128 v[16:19], v10 offset:0
  ds_read_b128 v[20:23], v10 offset:64
  ds_read_b128 v[24:27], v10 offset:128
  ds_read_b128 v[28:31], v10 offset:192
HOP29:
  s_cbranch_execz HOP45
  s_lshl_b32 s53, s45, 3
  s_lshl_b32 s54, s70, 2
  s_add_u32 s53, s53, s54
  s_mul_i32 s53, s53, 72
  s_lshl_b32 s54, s47, 1
  s_add_u32 s53, s53, s54
  s_add_u32 s53, s53, s71
  s_add_u32 s53, s53, 16
  s_lshl_b32 s72, s53, 10
  v_pk_mul_f32 v[6:7], v[6:7], v[6:7]
  v_pk_mul_f32 v[8:9], v[8:9], v[8:9]
  s_waitcnt lgkmcnt(0)
  v_pk_fma_f32 v[96:97], v[2:3], v[16:17], v[96:97] op_sel:[0,0,0] op_sel_hi:[0,1,1] neg_lo:[1,0,0] neg_hi:[1,0,0]
  v_pk_fma_f32 v[98:99], v[2:3], v[18:19], v[98:99] op_sel:[0,0,0] op_sel_hi:[0,1,1] neg_lo:[1,0,0] neg_hi:[1,0,0]
  v_pk_fma_f32 v[112:113], v[2:3], v[20:21], v[112:113] op_sel:[0,0,0] op_sel_hi:[0,1,1] neg_lo:[1,0,0] neg_hi:[1,0,0]
  v_pk_fma_f32 v[114:115], v[2:3], v[22:23], v[114:115] op_sel:[0,0,0] op_sel_hi:[0,1,1] neg_lo:[1,0,0] neg_hi:[1,0,0]
  v_pk_mul_f32 v[96:97], v[96:97], v[112:113]
  v_pk_mul_f32 v[98:99], v[98:99], v[114:115]
  v_pk_mul_f32 v[96:97], v[6:7], v[96:97] op_sel:[0,0] op_sel_hi:[0,1]
  v_pk_mul_f32 v[98:99], v[6:7], v[98:99] op_sel:[0,0] op_sel_hi:[0,1]
  v_cvt_pk_bf16_f32 v32, v96, v97
  v_cvt_pk_bf16_f32 v33, v98, v99
  v_pk_fma_f32 v[128:129], v[2:3], v[24:25], v[128:129] op_sel:[0,0,0] op_sel_hi:[0,1,1] neg_lo:[1,0,0] neg_hi:[1,0,0]
  v_pk_fma_f32 v[130:131], v[2:3], v[26:27], v[130:131] op_sel:[0,0,0] op_sel_hi:[0,1,1] neg_lo:[1,0,0] neg_hi:[1,0,0]
  v_pk_fma_f32 v[144:145], v[2:3], v[28:29], v[144:145] op_sel:[0,0,0] op_sel_hi:[0,1,1] neg_lo:[1,0,0] neg_hi:[1,0,0]
  v_pk_fma_f32 v[146:147], v[2:3], v[30:31], v[146:147] op_sel:[0,0,0] op_sel_hi:[0,1,1] neg_lo:[1,0,0] neg_hi:[1,0,0]
  v_pk_mul_f32 v[128:129], v[128:129], v[144:145]
  v_pk_mul_f32 v[130:131], v[130:131], v[146:147]
  v_pk_mul_f32 v[128:129], v[6:7], v[128:129] op_sel:[0,0] op_sel_hi:[0,1]
  v_pk_mul_f32 v[130:131], v[6:7], v[130:131] op_sel:[0,0] op_sel_hi:[0,1]
  v_cvt_pk_bf16_f32 v34, v128, v129
  v_cvt_pk_bf16_f32 v35, v130, v131
  s_add_u32 s56, s72, 0
  buffer_store_dwordx4 v[32:35], v11, s[40:43], s56 offen sc1
  v_pk_fma_f32 v[100:101], v[2:3], v[16:17], v[100:101] op_sel:[1,0,0] op_sel_hi:[1,1,1] neg_lo:[1,0,0] neg_hi:[1,0,0]
HOP30:
  s_cbranch_execz HOP46
  v_pk_fma_f32 v[102:103], v[2:3], v[18:19], v[102:103] op_sel:[1,0,0] op_sel_hi:[1,1,1] neg_lo:[1,0,0] neg_hi:[1,0,0]
  v_pk_fma_f32 v[116:117], v[2:3], v[20:21], v[116:117] op_sel:[1,0,0] op_sel_hi:[1,1,1] neg_lo:[1,0,0] neg_hi:[1,0,0]
  v_pk_fma_f32 v[118:119], v[2:3], v[22:23], v[118:119] op_sel:[1,0,0] op_sel_hi:[1,1,1] neg_lo:[1,0,0] neg_hi:[1,0,0]
  v_pk_mul_f32 v[100:101], v[100:101], v[116:117]
  v_pk_mul_f32 v[102:103], v[102:103], v[118:119]
  v_pk_mul_f32 v[100:101], v[6:7], v[100:101] op_sel:[1,0] op_sel_hi:[1,1]
  v_pk_mul_f32 v[102:103], v[6:7], v[102:103] op_sel:[1,0] op_sel_hi:[1,1]
  v_cvt_pk_bf16_f32 v36, v100, v101
  v_cvt_pk_bf16_f32 v37, v102, v103
  v_pk_fma_f32 v[132:133], v[2:3], v[24:25], v[132:133] op_sel:[1,0,0] op_sel_hi:[1,1,1] neg_lo:[1,0,0] neg_hi:[1,0,0]
  v_pk_fma_f32 v[134:135], v[2:3], v[26:27], v[134:135] op_sel:[1,0,0] op_sel_hi:[1,1,1] neg_lo:[1,0,0] neg_hi:[1,0,0]
  v_pk_fma_f32 v[148:149], v[2:3], v[28:29], v[148:149] op_sel:[1,0,0] op_sel_hi:[1,1,1] neg_lo:[1,0,0] neg_hi:[1,0,0]
  v_pk_fma_f32 v[150:151], v[2:3], v[30:31], v[150:151] op_sel:[1,0,0] op_sel_hi:[1,1,1] neg_lo:[1,0,0] neg_hi:[1,0,0]
  v_pk_mul_f32 v[132:133], v[132:133], v[148:149]
  v_pk_mul_f32 v[134:135], v[134:135], v[150:151]
  v_pk_mul_f32 v[132:133], v[6:7], v[132:133] op_sel:[1,0] op_sel_hi:[1,1]
  v_pk_mul_f32 v[134:135], v[6:7], v[134:135] op_sel:[1,0] op_sel_hi:[1,1]
  v_cvt_pk_bf16_f32 v38, v132, v133
  v_cvt_pk_bf16_f32 v39, v134, v135
  s_add_u32 s56, s72, 73728
  buffer_store_dwordx4 v[36:39], v11, s[40:43], s56 offen sc1
  v_pk_fma_f32 v[104:105], v[4:5], v[16:17], v[104:105] op_sel:[0,0,0] op_sel_hi:[0,1,1] neg_lo:[1,0,0] neg_hi:[1,0,0]
  v_pk_fma_f32 v[106:107], v[4:5], v[18:19], v[106:107] op_sel:[0,0,0] op_sel_hi:[0,1,1] neg_lo:[1,0,0] neg_hi:[1,0,0]
  v_pk_fma_f32 v[120:121], v[4:5], v[20:21], v[120:121] op_sel:[0,0,0] op_sel_hi:[0,1,1] neg_lo:[1,0,0] neg_hi:[1,0,0]
  v_pk_fma_f32 v[122:123], v[4:5], v[22:23], v[122:123] op_sel:[0,0,0] op_sel_hi:[0,1,1] neg_lo:[1,0,0] neg_hi:[1,0,0]
  v_pk_mul_f32 v[104:105], v[104:105], v[120:121]
  v_pk_mul_f32 v[106:107], v[106:107], v[122:123]
  v_pk_mul_f32 v[104:105], v[8:9], v[104:105] op_sel:[0,0] op_sel_hi:[0,1]
  v_pk_mul_f32 v[106:107], v[8:9], v[106:107] op_sel:[0,0] op_sel_hi:[0,1]
  v_cvt_pk_bf16_f32 v32, v104, v105
HOP31:
  s_cbranch_execz HOP47
  v_cvt_pk_bf16_f32 v33, v106, v107
  v_pk_fma_f32 v[136:137], v[4:5], v[24:25], v[136:137] op_sel:[0,0,0] op_sel_hi:[0,1,1] neg_lo:[1,0,0] neg_hi:[1,0,0]
  v_pk_fma_f32 v[138:139], v[4:5], v[26:27], v[138:139] op_sel:[0,0,0] op_sel_hi:[0,1,1] neg_lo:[1,0,0] neg_hi:[1,0,0]
  v_pk_fma_f32 v[152:153], v[4:5], v[28:29], v[152:153] op_sel:[0,0,0] op_sel_hi:[0,1,1] neg_lo:[1,0,0] neg_hi:[1,0,0]
  v_pk_fma_f32 v[154:155], v[4:5], v[30:31], v[154:155] op_sel:[0,0,0] op_sel_hi:[0,1,1] neg_lo:[1,0,0] neg_hi:[1,0,0]
  v_pk_mul_f32 v[136:137], v[136:137], v[152:153]
  v_pk_mul_f32 v[138:139], v[138:139], v[154:155]
  v_pk_mul_f32 v[136:137], v[8:9], v[136:137] op_sel:[0,0] op_sel_hi:[0,1]
  v_pk_mul_f32 v[138:139], v[8:9], v[138:139] op_sel:[0,0] op_sel_hi:[0,1]
  v_cvt_pk_bf16_f32 v34, v136, v137
  v_cvt_pk_bf16_f32 v35, v138, v139
  s_add_u32 s56, s72, 147456
  buffer_store_dwordx4 v[32:35], v11, s[40:43], s56 offen sc1
  v_pk_fma_f32 v[108:109], v[4:5], v[16:17], v[108:109] op_sel:[1,0,0] op_sel_hi:[1,1,1] neg_lo:[1,0,0] neg_hi:[1,0,0]
  v_pk_fma_f32 v[110:111], v[4:5], v[18:19], v[110:111] op_sel:[1,0,0] op_sel_hi:[1,1,1] neg_lo:[1,0,0] neg_hi:[1,0,0]
  v_pk_fma_f32 v[124:125], v[4:5], v[20:21], v[124:125] op_sel:[1,0,0] op_sel_hi:[1,1,1] neg_lo:[1,0,0] neg_hi:[1,0,0]
  v_pk_fma_f32 v[126:127], v[4:5], v[22:23], v[126:127] op_sel:[1,0,0] op_sel_hi:[1,1,1] neg_lo:[1,0,0] neg_hi:[1,0,0]
  v_pk_mul_f32 v[108:109], v[108:109], v[124:125]
  v_pk_mul_f32 v[110:111], v[110:111], v[126:127]
  v_pk_mul_f32 v[108:109], v[8:9], v[108:109] op_sel:[1,0] op_sel_hi:[1,1]
  v_pk_mul_f32 v[110:111], v[8:9], v[110:111] op_sel:[1,0] op_sel_hi:[1,1]
  v_cvt_pk_bf16_f32 v36, v108, v109
  v_cvt_pk_bf16_f32 v37, v110, v111
  v_pk_fma_f32 v[140:141], v[4:5], v[24:25], v[140:141] op_sel:[1,0,0] op_sel_hi:[1,1,1] neg_lo:[1,0,0] neg_hi:[1,0,0]
  v_pk_fma_f32 v[142:143], v[4:5], v[26:27], v[142:143] op_sel:[1,0,0] op_sel_hi:[1,1,1] neg_lo:[1,0,0] neg_hi:[1,0,0]
  v_pk_fma_f32 v[156:157], v[4:5], v[28:29], v[156:157] op_sel:[1,0,0] op_sel_hi:[1,1,1] neg_lo:[1,0,0] neg_hi:[1,0,0]
  v_pk_fma_f32 v[158:159], v[4:5], v[30:31], v[158:159] op_sel:[1,0,0] op_sel_hi:[1,1,1] neg_lo:[1,0,0] neg_hi:[1,0,0]
  v_pk_mul_f32 v[140:141], v[140:141], v[156:157]
  v_pk_mul_f32 v[142:143], v[142:143], v[158:159]
  v_pk_mul_f32 v[140:141], v[8:9], v[140:141] op_sel:[1,0] op_sel_hi:[1,1]
HOP32:
  s_cbranch_execz HOP48
  v_pk_mul_f32 v[142:143], v[8:9], v[142:143] op_sel:[1,0] op_sel_hi:[1,1]
  v_cvt_pk_bf16_f32 v38, v140, v141
  v_cvt_pk_bf16_f32 v39, v142, v143
  s_add_u32 s56, s72, 221184
  buffer_store_dwordx4 v[36:39], v11, s[40:43], s56 offen sc1
  s_branch L_cmp_pub
L_h67:
  s_waitcnt lgkmcnt(0)
  s_mov_b32 s40, s20
  s_mov_b32 s41, s21
  s_mov_b32 s42, 12058624
  s_mov_b32 s43, 0x20000
  s_lshr_b32 s66, s50, 1
  s_bitcmp1_b32 s50, 0
  s_cselect_b32 s53, 0, 16
  s_add_u32 s66, s66, s53
  s_mul_i32 s53, s66, 37
  s_lshr_b32 s53, s53, 8
  s_mul_i32 s54, s53, 7
  s_sub_u32 s65, s66, s54
  s_lshl_b32 s64, s49, 2
  s_add_u32 s64, s64, s53
  s_and_b32 s53, s64, 3
  s_lshl_b32 s53, s53, 1
  s_and_b32 s54, s65, 1
  s_lshl_b32 s54, s54, 2
  s_add_u32 s53, s53, s54
  s_add_u32 s61, s44, s53
  s_and_b32 s61, s61, 7
  s_cmp_eq_u32 s44, 6
  s_cbranch_scc0 L_h7
L_h6:
HOP33:
  s_cbranch_execz HOP49
  v_mov_b32 v1, 11931648
  buffer_load_dword v2, v1, s[40:43], 0 offen sc1
  v_mov_b32 v16, 0x3f803f80
  v_mov_b32 v17, 0x3f803f80
  v_mov_b32 v18, 0x3f803f80
  v_mov_b32 v19, 0x3f803f80
  s_cmp_ge_u32 s45, 7
  s_cselect_b32 s70, 1, 0
  s_cmp_lt_u32 s45, 14
  s_cbranch_scc0 L_h6np
  s_bitcmp1_b32 s46, 0
  s_cbranch_scc1 L_h6Q
  v_lshrrev_b32 v20, 4, v0
  v_bfe_u32 v21, v0, 2, 2
  v_and_b32 v22, 3, v0
  v_lshlrev_b32 v22, 3, v22
  v_lshrrev_b32 v23, 1, v21
  v_and_b32 v24, 1, v20
  v_lshlrev_b32 v25, 3, v20
  v_add_u32 v25, v25, v21
  v_mul_u32_u24 v26, 384, v25
  v_xor_b32 v27, s70, v23
  v_lshlrev_b32 v27, 6, v27
  v_add3_u32 v26, v26, v27, v22
  v_lshlrev_b32 v27, 5, v24
  v_add_u32 v10, v26, v27
  v_sub_u32 v11, v26, v27
  v_add_u32 v11, 32, v11
  v_lshlrev_b32 v26, 7, v25
  v_xor_b32 v27, s70, v24
  v_lshlrev_b32 v27, 6, v27
  v_add3_u32 v26, v26, v27, v22
  v_lshlrev_b32 v27, 5, v23
  v_add_u32 v12, v26, v27
  v_sub_u32 v13, v26, v27
  v_add_u32 v13, 32, v13
  s_barrier
  ds_read_b64_tr_b16 v[64:65], v12 offset:12288
  ds_read_b64_tr_b16 v[66:67], v12 offset:12800
  ds_read_b64_tr_b16 v[68:69], v12 offset:16448
  ds_read_b64_tr_b16 v[70:71], v12 offset:16960
  ds_read_b64_tr_b16 v[72:73], v13 offset:12288
  ds_read_b64_tr_b16 v[74:75], v13 offset:12800
  ds_read_b64_tr_b16 v[76:77], v13 offset:16448
HOP34:
  s_cbranch_execz HOP50
  ds_read_b64_tr_b16 v[78:79], v13 offset:16960
  ds_read_b64_tr_b16 v[80:81], v10 offset:0
  ds_read_b64_tr_b16 v[82:83], v10 offset:1536
  ds_read_b64_tr_b16 v[84:85], v11 offset:0
  ds_read_b64_tr_b16 v[86:87], v11 offset:1536
  ds_read_b64_tr_b16 v[88:89], v10 offset:128
  ds_read_b64_tr_b16 v[90:91], v10 offset:1664
  ds_read_b64_tr_b16 v[92:93], v11 offset:128
  ds_read_b64_tr_b16 v[94:95], v11 offset:1664
  ds_read_b64_tr_b16 v[96:97], v10 offset:256
  ds_read_b64_tr_b16 v[98:99], v10 offset:1792
  ds_read_b64_tr_b16 v[100:101], v11 offset:256
  ds_read_b64_tr_b16 v[102:103], v11 offset:1792
  s_barrier
  s_waitcnt lgkmcnt(0)
  v_mfma_f32_16x16x32_bf16 v[144:147], v[16:19], v[64:67], 0
  v_mfma_f32_16x16x32_bf16 v[148:151], v[16:19], v[68:71], 0
  v_mfma_f32_16x16x32_bf16 v[152:155], v[16:19], v[72:75], 0
  v_mfma_f32_16x16x32_bf16 v[156:159], v[16:19], v[76:79], 0
  v_mfma_f32_16x16x32_bf16 v[160:163], v[16:19], v[80:83], 0
  v_mfma_f32_16x16x32_bf16 v[164:167], v[16:19], v[84:87], 0
  v_mfma_f32_16x16x32_bf16 v[168:171], v[16:19], v[88:91], 0
  v_mfma_f32_16x16x32_bf16 v[172:175], v[16:19], v[92:95], 0
  v_mfma_f32_16x16x32_bf16 v[176:179], v[16:19], v[96:99], 0
  v_mfma_f32_16x16x32_bf16 v[180:183], v[16:19], v[100:103], 0
  ds_read_b64_tr_b16 v[64:65], v12 offset:33024
  ds_read_b64_tr_b16 v[66:67], v12 offset:33536
  ds_read_b64_tr_b16 v[68:69], v12 offset:37184
  ds_read_b64_tr_b16 v[70:71], v12 offset:37696
  ds_read_b64_tr_b16 v[72:73], v13 offset:33024
  ds_read_b64_tr_b16 v[74:75], v13 offset:33536
HOP35:
  s_cbranch_execz HOP51
  ds_read_b64_tr_b16 v[76:77], v13 offset:37184
  ds_read_b64_tr_b16 v[78:79], v13 offset:37696
  ds_read_b64_tr_b16 v[80:81], v10 offset:20736
  ds_read_b64_tr_b16 v[82:83], v10 offset:22272
  ds_read_b64_tr_b16 v[84:85], v11 offset:20736
  ds_read_b64_tr_b16 v[86:87], v11 offset:22272
  ds_read_b64_tr_b16 v[88:89], v10 offset:20864
  ds_read_b64_tr_b16 v[90:91], v10 offset:22400
  ds_read_b64_tr_b16 v[92:93], v11 offset:20864
  ds_read_b64_tr_b16 v[94:95], v11 offset:22400
  ds_read_b64_tr_b16 v[96:97], v10 offset:20992
  ds_read_b64_tr_b16 v[98:99], v10 offset:22528
  ds_read_b64_tr_b16 v[100:101], v11 offset:20992
  ds_read_b64_tr_b16 v[102:103], v11 offset:22528
  s_branch L_h6j
L_h6Q:
  v_lshrrev_b32 v20, 4, v0
  v_bfe_u32 v21, v0, 2, 2
  v_and_b32 v22, 3, v0
  v_lshlrev_b32 v22, 3, v22
  v_lshrrev_b32 v23, 1, v21
  v_and_b32 v24, 1, v20
  v_lshlrev_b32 v25, 3, v20
  v_add_u32 v25, v25, v21
  v_mul_u32_u24 v26, 320, v25
  s_mul_i32 s53, s70, 160
  v_add3_u32 v26, v26, v22, s53
  v_lshlrev_b32 v28, 5, v24
  s_cmp_eq_u32 s70, 0
  s_cselect_b32 s53, 1, -1
  v_mul_lo_u32 v28, v28, s53
  v_add_u32 v10, v26, v28
  v_sub_u32 v11, v26, v28
  s_barrier
  ds_read_b64_tr_b16 v[64:65], v10 offset:0
  ds_read_b64_tr_b16 v[66:67], v10 offset:1280
  ds_read_b64_tr_b16 v[68:69], v10 offset:10272
  ds_read_b64_tr_b16 v[70:71], v10 offset:11552
HOP36:
  s_cbranch_execz HOP52
  ds_read_b64_tr_b16 v[72:73], v11 offset:32
  ds_read_b64_tr_b16 v[74:75], v11 offset:1312
  ds_read_b64_tr_b16 v[76:77], v11 offset:10304
  ds_read_b64_tr_b16 v[78:79], v11 offset:11584
  ds_read_b64_tr_b16 v[80:81], v10 offset:64
  ds_read_b64_tr_b16 v[82:83], v10 offset:1344
  ds_read_b64_tr_b16 v[84:85], v10 offset:10336
  ds_read_b64_tr_b16 v[86:87], v10 offset:11616
  ds_read_b64_tr_b16 v[88:89], v11 offset:96
  ds_read_b64_tr_b16 v[90:91], v11 offset:1376
  ds_read_b64_tr_b16 v[92:93], v11 offset:10368
  ds_read_b64_tr_b16 v[94:95], v11 offset:11648
  ds_read_b64_tr_b16 v[96:97], v10 offset:128
  ds_read_b64_tr_b16 v[98:99], v10 offset:1408
  ds_read_b64_tr_b16 v[100:101], v10 offset:10400
  ds_read_b64_tr_b16 v[102:103], v10 offset:11680
  s_barrier
  s_waitcnt lgkmcnt(0)
  v_mfma_f32_16x16x32_bf16 v[144:147], v[16:19], v[64:67], 0
  v_mfma_f32_16x16x32_bf16 v[148:151], v[16:19], v[68:71], 0
  v_mfma_f32_16x16x32_bf16 v[152:155], v[16:19], v[72:75], 0
  v_mfma_f32_16x16x32_bf16 v[156:159], v[16:19], v[76:79], 0
  v_mfma_f32_16x16x32_bf16 v[160:163], v[16:19], v[80:83], 0
  v_mfma_f32_16x16x32_bf16 v[164:167], v[16:19], v[84:87], 0
  v_mfma_f32_16x16x32_bf16 v[168:171], v[16:19], v[88:91], 0
  v_mfma_f32_16x16x32_bf16 v[172:175], v[16:19], v[92:95], 0
  v_mfma_f32_16x16x32_bf16 v[176:179], v[16:19], v[96:99], 0
  v_mfma_f32_16x16x32_bf16 v[180:183], v[16:19], v[100:103], 0
  ds_read_b64_tr_b16 v[64:65], v10 offset:20736
  ds_read_b64_tr_b16 v[66:67], v10 offset:22016
  ds_read_b64_tr_b16 v[68:69], v10 offset:31008
HOP37:
  s_cbranch_execz HOP53
  ds_read_b64_tr_b16 v[70:71], v10 offset:32288
  ds_read_b64_tr_b16 v[72:73], v11 offset:20768
  ds_read_b64_tr_b16 v[74:75], v11 offset:22048
  ds_read_b64_tr_b16 v[76:77], v11 offset:31040
  ds_read_b64_tr_b16 v[78:79], v11 offset:32320
  ds_read_b64_tr_b16 v[80:81], v10 offset:20800
  ds_read_b64_tr_b16 v[82:83], v10 offset:22080
  ds_read_b64_tr_b16 v[84:85], v10 offset:31072
  ds_read_b64_tr_b16 v[86:87], v10 offset:32352
  ds_read_b64_tr_b16 v[88:89], v11 offset:20832
  ds_read_b64_tr_b16 v[90:91], v11 offset:22112
  ds_read_b64_tr_b16 v[92:93], v11 offset:31104
  ds_read_b64_tr_b16 v[94:95], v11 offset:32384
  ds_read_b64_tr_b16 v[96:97], v10 offset:20864
  ds_read_b64_tr_b16 v[98:99], v10 offset:22144
  ds_read_b64_tr_b16 v[100:101], v10 offset:31136
  ds_read_b64_tr_b16 v[102:103], v10 offset:32416
L_h6j:
  s_barrier
  s_waitcnt lgkmcnt(0)
  v_mfma_f32_16x16x32_bf16 v[144:147], v[16:19], v[64:67], v[144:147]
  v_mfma_f32_16x16x32_bf16 v[148:151], v[16:19], v[68:71], v[148:151]
  v_mfma_f32_16x16x32_bf16 v[152:155], v[16:19], v[72:75], v[152:155]
  v_mfma_f32_16x16x32_bf16 v[156:159], v[16:19], v[76:79], v[156:159]
  v_mfma_f32_16x16x32_bf16 v[160:163], v[16:19], v[80:83], v[160:163]
  v_mfma_f32_16x16x32_bf16 v[164:167], v[16:19], v[84:87], v[164:167]
  v_mfma_f32_16x16x32_bf16 v[168:171], v[16:19], v[88:91], v[168:171]
  v_mfma_f32_16x16x32_bf16 v[172:175], v[16:19], v[92:95], v[172:175]
  v_mfma_f32_16x16x32_bf16 v[176:179], v[16:19], v[96:99], v[176:179]
  v_mfma_f32_16x16x32_bf16 v[180:183], v[16:19], v[100:103], v[180:183]
  s_mov_b32 s74, 0xffff0000
  s_mov_b32 s75, 0
  s_mov_b32 s76, 0
HOP38:
  s_cbranch_execz HOP54
  s_mov_b32 s77, 0xffff
  s_mov_b32 s78, 0
  s_mov_b32 s79, 0xffff0000
  s_mul_i32 s55, s46, 7
  s_add_u32 s55, s55, s48
  s_mul_i32 s55, s55, 1280
  s_mul_i32 s54, s70, 640
  s_add_u32 s55, s55, s54
  s_add_u32 s55, s55, 11534336
  v_lshlrev_b32 v20, 2, v0
  v_cndmask_b32 v21, v144, v148, s[74:75]
  v_cndmask_b32 v21, v21, v152, s[76:77]
  v_cndmask_b32 v24, v21, v156, s[78:79]
  v_cndmask_b32 v21, v160, v164, s[74:75]
  v_cndmask_b32 v21, v21, v168, s[76:77]
  v_cndmask_b32 v25, v21, v172, s[78:79]
  v_cndmask_b32 v26, v176, v180, s[74:75]
  s_waitcnt vmcnt(0)
  buffer_store_dword v24, v20, s[40:43], s55 offen offset:0 sc1
  buffer_store_dword v25, v20, s[40:43], s55 offen offset:256 sc1
  s_mov_b64 s[74:75], exec
  s_mov_b32 exec_hi, 0
  buffer_store_dword v26, v20, s[40:43], s55 offen offset:512 sc1
  s_mov_b64 exec, s[74:75]
  s_branch L_h6k
L_h6np:
  s_barrier
  s_barrier
  s_barrier
  s_waitcnt vmcnt(0)
L_h6k:
  v_readfirstlane_b32 s67, v2
  s_nop 0
  s_add_u32 s67, s67, 1
  s_barrier
  s_lshl_b32 s53, s45, 4
  s_add_u32 s54, s53, s46
  v_mov_b32 v3, s54
  v_add_u32 v4, s53, v0
  v_cmp_gt_u32 vcc, 16, v0
  s_sub_u32 s55, s53, 16
  s_max_i32 s55, s55, 0
  v_cndmask_b32 v3, v3, v4, vcc
  v_add_u32 v4, -2, v0
  v_add_u32 v4, s55, v4
  v_and_b32 v5, 62, v0
  v_cmp_eq_u32 vcc, 16, v5
HOP39:
  s_cbranch_execz HOP55
  v_add_u32 v5, -18, v0
  v_lshlrev_b32 v6, 4, v5
  v_cndmask_b32 v3, v3, v4, vcc
  v_add_u32 v6, s46, v6
  v_cmp_gt_u32 vcc, 14, v5
  v_and_b32 v7, 7, v0
  v_bfe_u32 v8, v0, 3, 2
  v_cndmask_b32 v3, v3, v6, vcc
  v_mul_u32_u24 v8, 7, v8
  v_add_u32 v8, s65, v8
  v_lshlrev_b32 v9, 1, v8
  v_add_u32 v10, 1, v9
  v_add_u32 v9, -32, v9
  v_cmp_gt_u32 vcc, 16, v8
  v_and_b32 v11, 1, v7
  v_lshlrev_b32 v11, 3, v11
  v_cndmask_b32 v9, v9, v10, vcc
  v_lshrrev_b32 v10, 2, v9
  v_add_u32 v11, v11, v10
  v_lshlrev_b32 v11, 4, v11
  v_lshrrev_b32 v7, 1, v7
  v_lshlrev_b32 v7, 2, v7
  v_and_b32 v9, 3, v9
  v_add3_u32 v11, v11, v7, v9
  v_lshlrev_b32 v3, 7, v3
  v_lshlrev_b32 v11, 7, v11
  v_add_u32 v22, 11993088, v3
  v_add_u32 v23, 11993092, v11
  v_cmp_le_u32 vcc, 32, v0
  s_nop 1
  v_cndmask_b32 v22, v22, v23, vcc
  v_mov_b32 v1, 152960
  v_mov_b32 v2, s67
  v_mov_b32 v3, 0
  ds_write_b32 v1, v2
  ds_write_b32 v1, v3 offset:4
  ds_write_b32 v1, v3 offset:8
  s_barrier
  s_waitcnt vmcnt(0) lgkmcnt(0)
  s_barrier
  s_lshl_b32 s53, s45, 4
  s_add_u32 s53, s53, s46
  s_lshl_b32 s53, s53, 7
  s_add_u32 s53, s53, 11993088
  v_mov_b32 v1, s53
  v_mov_b32 v2, s67
  v_cmp_eq_u32 vcc, 0, v0
  s_nop 0
  s_and_saveexec_b64 s[74:75], vcc
HOP40:
  s_cbranch_execz HOP56
  buffer_store_dword v2, v1, s[40:43], 0 offen sc1
  s_mov_b64 exec, s[74:75]
  s_barrier
  s_barrier
  s_barrier
  s_barrier
  buffer_load_dword v4, v22, s[40:43], 0 offen sc1
  s_barrier
  s_barrier
  s_mov_b32 s53, 0
L_pa:
  s_waitcnt vmcnt(0)
  v_cmp_eq_u32 vcc, s67, v4
  s_add_u32 s53, s53, 1
  s_cmp_eq_u64 vcc, exec
  s_cbranch_scc1 L_pad
  s_sleep 4
  buffer_load_dword v4, v22, s[40:43], 0 offen sc1
  s_cmp_lt_u32 s53, 0x8000
  s_cbranch_scc1 L_pa
L_pad:
  s_sub_u32 s53, s68, 16
  v_add_u32 v1, 0, v0
  v_add_u32 v1, s53, v1
  v_max_i32 v1, 0, v1
  v_min_i32 v1, 2047, v1
  v_lshlrev_b32 v1, 3, v1
  v_add_u32 v8, 11862016, v1
  buffer_load_dwordx2 v[12:13], v8, s[40:43], 0 offen sc1
  v_add_u32 v1, 64, v0
  v_add_u32 v1, s53, v1
  v_max_i32 v1, 0, v1
  v_min_i32 v1, 2047, v1
  v_lshlrev_b32 v1, 3, v1
  v_add_u32 v9, 11862016, v1
  buffer_load_dwordx2 v[14:15], v9, s[40:43], 0 offen sc1
  v_add_u32 v1, 128, v0
  v_add_u32 v1, s53, v1
  v_max_i32 v1, 0, v1
  v_min_i32 v1, 2047, v1
  v_lshlrev_b32 v1, 3, v1
  v_add_u32 v10, 11862016, v1
  buffer_load_dwordx2 v[16:17], v10, s[40:43], 0 offen sc1
  s_mul_i32 s55, s46, 8960
  s_add_u32 s55, s55, 11534336
  v_lshrrev_b32 v1, 4, v0
HOP41:
  s_cbranch_execz HOP57
  v_mul_u32_u24 v1, 1280, v1
  v_and_b32 v2, 15, v0
  v_lshlrev_b32 v2, 4, v2
  v_add3_u32 v21, v1, v2, 0
  v_add_u32 v21, 1024, v21
  buffer_load_dwordx4 v[92:95], v21, s[40:43], s55 offen sc1
  s_add_u32 s56, s55, 5120
  buffer_load_dwordx4 v[96:99], v21, s[40:43], s56 offen sc1
  s_barrier
  s_barrier
  s_barrier
  s_waitcnt vmcnt(0)
  v_lshlrev_b32 v1, 2, v0
  v_add_u32 v1, 150528, v1
  ds_write_b32 v1, v12
  ds_write_b32 v1, v13 offset:576
  ds_write_b32 v1, v14 offset:256
  ds_write_b32 v1, v15 offset:832
  v_cmp_gt_u32 vcc, 16, v0
  s_nop 0
  s_and_saveexec_b64 s[74:75], vcc
  ds_write_b32 v1, v16 offset:512
  ds_write_b32 v1, v17 offset:1088
  s_mov_b64 exec, s[74:75]
  v_cmp_gt_u32 vcc, 48, v0
  s_nop 1
  v_cndmask_b32 v96, 0, v96, vcc
  v_cndmask_b32 v97, 0, v97, vcc
  v_cndmask_b32 v98, 0, v98, vcc
  v_cndmask_b32 v99, 0, v99, vcc
  v_pk_add_f32 v[92:93], v[92:93], v[96:97]
  v_pk_add_f32 v[94:95], v[94:95], v[98:99]
  v_mov_b32 v100, v92
  v_mov_b32 v101, v93
  v_mov_b32 v102, v94
  v_mov_b32 v103, v95
  s_nop 1
  v_permlane32_swap_b32 v100, v92
  v_permlane32_swap_b32 v101, v93
  v_permlane32_swap_b32 v102, v94
  v_permlane32_swap_b32 v103, v95
  v_add_f32 v92, v92, v100
  v_add_f32 v93, v93, v101
  v_add_f32 v94, v94, v102
  v_add_f32 v95, v95, v103
HOP42:
  s_cbranch_execz HOP58
  v_mov_b32 v100, v92
  v_mov_b32 v101, v93
  v_mov_b32 v102, v94
  v_mov_b32 v103, v95
  s_nop 1
  v_permlane16_swap_b32 v100, v92
  v_permlane16_swap_b32 v101, v93
  v_permlane16_swap_b32 v102, v94
  v_permlane16_swap_b32 v103, v95
  v_add_f32 v92, v92, v100
  v_add_f32 v93, v93, v101
  v_add_f32 v94, v94, v102
  v_add_f32 v95, v95, v103
  v_add_u32 v20, 152704, v2
  v_cmp_gt_u32 vcc, 16, v0
  s_nop 0
  s_and_saveexec_b64 s[74:75], vcc
  ds_write_b128 v20, v[92:95]
  s_mov_b64 exec, s[74:75]
  s_waitcnt lgkmcnt(0)
  s_branch L_tail_help
L_h7:
HOP43:
  s_cbranch_execz HOP59
  s_mov_b32 s32, s4
  s_mov_b32 s33, s5
  s_mov_b32 s34, 1835008
  s_mov_b32 s35, 0x20000
  s_lshl_b32 s53, s46, 3
  s_add_u32 s53, s53, s68
  v_lshrrev_b32 v3, 3, v0
  v_add_u32 v3, s53, v3
  v_and_b32 v8, 7, v0
  v_lshlrev_b32 v8, 4, v8
  v_mul_u32_u24 v9, 896, v3
  v_add_u32 v8, v8, v9
  buffer_load_dwordx4 v[224:227], v8, s[32:35], 0 offen offset:0
  buffer_load_dwordx4 v[228:231], v8, s[32:35], 0 offen offset:128
  buffer_load_dwordx4 v[232:235], v8, s[32:35], 0 offen offset:256
  buffer_load_dwordx4 v[236:239], v8, s[32:35], 0 offen offset:384
  buffer_load_dwordx4 v[240:243], v8, s[32:35], 0 offen offset:512
  buffer_load_dwordx4 v[244:247], v8, s[32:35], 0 offen offset:640
  buffer_load_dwordx4 v[248:251], v8, s[32:35], 0 offen offset:768
  s_mov_b32 s24, s8
  s_mov_b32 s25, s9
  s_mov_b32 s26, 401408
  s_mov_b32 s27, 0x20000
  s_mov_b32 s28, s16
  s_mov_b32 s29, s17
  s_mov_b32 s30, 1605632
  s_mov_b32 s31, 0x20000
  v_lshlrev_b32 v252, 3, v3
  v_add_u32 v252, 11862016, v252
  v_mov_b32 v10, 0
  v_mov_b32 v11, 0
  v_mov_b32 v12, 0
  v_mov_b32 v13, 0
  v_lshrrev_b32 v1, 3, v0
  v_bfe_u32 v2, v1, 1, 2
  v_lshlrev_b32 v2, 1, v2
  v_and_b32 v3, 7, v0
  v_xor_b32 v2, v2, v3
  v_lshlrev_b32 v2, 4, v2
  v_mul_u32_u24 v1, 896, v1
  s_lshl_b32 s53, s65, 7
  v_add3_u32 v8, v1, v2, s53
HOP44:
  s_cbranch_execz HOP60
  s_waitcnt vmcnt(0)
  v_lshlrev_b32 v14, 16, v224
  v_and_b32 v15, 0xffff0000, v224
  v_pk_add_f32 v[10:11], v[10:11], v[14:15]
  v_pk_fma_f32 v[12:13], v[14:15], v[14:15], v[12:13]
  v_lshlrev_b32 v14, 16, v225
  v_and_b32 v15, 0xffff0000, v225
  v_pk_add_f32 v[10:11], v[10:11], v[14:15]
  v_pk_fma_f32 v[12:13], v[14:15], v[14:15], v[12:13]
  v_lshlrev_b32 v14, 16, v226
  v_and_b32 v15, 0xffff0000, v226
  v_pk_add_f32 v[10:11], v[10:11], v[14:15]
  v_pk_fma_f32 v[12:13], v[14:15], v[14:15], v[12:13]
  v_lshlrev_b32 v14, 16, v227
  v_and_b32 v15, 0xffff0000, v227
  v_pk_add_f32 v[10:11], v[10:11], v[14:15]
  v_pk_fma_f32 v[12:13], v[14:15], v[14:15], v[12:13]
  v_lshlrev_b32 v14, 16, v228
  v_and_b32 v15, 0xffff0000, v228
  v_pk_add_f32 v[10:11], v[10:11], v[14:15]
  v_pk_fma_f32 v[12:13], v[14:15], v[14:15], v[12:13]
  v_lshlrev_b32 v14, 16, v229
  v_and_b32 v15, 0xffff0000, v229
  v_pk_add_f32 v[10:11], v[10:11], v[14:15]
  v_pk_fma_f32 v[12:13], v[14:15], v[14:15], v[12:13]
  v_lshlrev_b32 v14, 16, v230
  v_and_b32 v15, 0xffff0000, v230
  v_pk_add_f32 v[10:11], v[10:11], v[14:15]
  v_pk_fma_f32 v[12:13], v[14:15], v[14:15], v[12:13]
  v_lshlrev_b32 v14, 16, v231
  v_and_b32 v15, 0xffff0000, v231
  v_pk_add_f32 v[10:11], v[10:11], v[14:15]
  v_pk_fma_f32 v[12:13], v[14:15], v[14:15], v[12:13]
  v_lshlrev_b32 v14, 16, v232
  v_and_b32 v15, 0xffff0000, v232
HOP45:
  s_cbranch_execz HOP61
  v_pk_add_f32 v[10:11], v[10:11], v[14:15]
  v_pk_fma_f32 v[12:13], v[14:15], v[14:15], v[12:13]
  v_lshlrev_b32 v14, 16, v233
  v_and_b32 v15, 0xffff0000, v233
  v_pk_add_f32 v[10:11], v[10:11], v[14:15]
  v_pk_fma_f32 v[12:13], v[14:15], v[14:15], v[12:13]
  v_lshlrev_b32 v14, 16, v234
  v_and_b32 v15, 0xffff0000, v234
  v_pk_add_f32 v[10:11], v[10:11], v[14:15]
  v_pk_fma_f32 v[12:13], v[14:15], v[14:15], v[12:13]
  v_lshlrev_b32 v14, 16, v235
  v_and_b32 v15, 0xffff0000, v235
  v_pk_add_f32 v[10:11], v[10:11], v[14:15]
  v_pk_fma_f32 v[12:13], v[14:15], v[14:15], v[12:13]
  v_lshlrev_b32 v14, 16, v236
  v_and_b32 v15, 0xffff0000, v236
  v_pk_add_f32 v[10:11], v[10:11], v[14:15]
  v_pk_fma_f32 v[12:13], v[14:15], v[14:15], v[12:13]
  v_lshlrev_b32 v14, 16, v237
  v_and_b32 v15, 0xffff0000, v237
  v_pk_add_f32 v[10:11], v[10:11], v[14:15]
  v_pk_fma_f32 v[12:13], v[14:15], v[14:15], v[12:13]
  v_lshlrev_b32 v14, 16, v238
  v_and_b32 v15, 0xffff0000, v238
  v_pk_add_f32 v[10:11], v[10:11], v[14:15]
  v_pk_fma_f32 v[12:13], v[14:15], v[14:15], v[12:13]
  v_lshlrev_b32 v14, 16, v239
  v_and_b32 v15, 0xffff0000, v239
  v_pk_add_f32 v[10:11], v[10:11], v[14:15]
  v_pk_fma_f32 v[12:13], v[14:15], v[14:15], v[12:13]
  v_lshlrev_b32 v14, 16, v240
  v_and_b32 v15, 0xffff0000, v240
  v_pk_add_f32 v[10:11], v[10:11], v[14:15]
  v_pk_fma_f32 v[12:13], v[14:15], v[14:15], v[12:13]
HOP46:
  s_cbranch_execz HOP62
  v_lshlrev_b32 v14, 16, v241
  v_and_b32 v15, 0xffff0000, v241
  v_pk_add_f32 v[10:11], v[10:11], v[14:15]
  v_pk_fma_f32 v[12:13], v[14:15], v[14:15], v[12:13]
  v_lshlrev_b32 v14, 16, v242
  v_and_b32 v15, 0xffff0000, v242
  v_pk_add_f32 v[10:11], v[10:11], v[14:15]
  v_pk_fma_f32 v[12:13], v[14:15], v[14:15], v[12:13]
  v_lshlrev_b32 v14, 16, v243
  v_and_b32 v15, 0xffff0000, v243
  v_pk_add_f32 v[10:11], v[10:11], v[14:15]
  v_pk_fma_f32 v[12:13], v[14:15], v[14:15], v[12:13]
  v_lshlrev_b32 v14, 16, v244
  v_and_b32 v15, 0xffff0000, v244
  v_pk_add_f32 v[10:11], v[10:11], v[14:15]
  v_pk_fma_f32 v[12:13], v[14:15], v[14:15], v[12:13]
  v_lshlrev_b32 v14, 16, v245
  v_and_b32 v15, 0xffff0000, v245
  v_pk_add_f32 v[10:11], v[10:11], v[14:15]
  v_pk_fma_f32 v[12:13], v[14:15], v[14:15], v[12:13]
  v_lshlrev_b32 v14, 16, v246
  v_and_b32 v15, 0xffff0000, v246
  v_pk_add_f32 v[10:11], v[10:11], v[14:15]
  v_pk_fma_f32 v[12:13], v[14:15], v[14:15], v[12:13]
  v_lshlrev_b32 v14, 16, v247
  v_and_b32 v15, 0xffff0000, v247
  v_pk_add_f32 v[10:11], v[10:11], v[14:15]
  v_pk_fma_f32 v[12:13], v[14:15], v[14:15], v[12:13]
  v_lshlrev_b32 v14, 16, v248
  v_and_b32 v15, 0xffff0000, v248
  v_pk_add_f32 v[10:11], v[10:11], v[14:15]
  v_pk_fma_f32 v[12:13], v[14:15], v[14:15], v[12:13]
  v_lshlrev_b32 v14, 16, v249
  v_and_b32 v15, 0xffff0000, v249
  v_pk_add_f32 v[10:11], v[10:11], v[14:15]
HOP47:
  s_cbranch_execz HOP63
  v_pk_fma_f32 v[12:13], v[14:15], v[14:15], v[12:13]
  v_lshlrev_b32 v14, 16, v250
  v_and_b32 v15, 0xffff0000, v250
  v_pk_add_f32 v[10:11], v[10:11], v[14:15]
  v_pk_fma_f32 v[12:13], v[14:15], v[14:15], v[12:13]
  v_lshlrev_b32 v14, 16, v251
  v_and_b32 v15, 0xffff0000, v251
  v_pk_add_f32 v[10:11], v[10:11], v[14:15]
  v_pk_fma_f32 v[12:13], v[14:15], v[14:15], v[12:13]
  v_add_f32 v10, v10, v11
  v_add_f32 v12, v12, v13
  s_nop 1
  v_add_f32_dpp v10, v10, v10 quad_perm:[1,0,3,2] row_mask:0xf bank_mask:0xf
  v_add_f32_dpp v12, v12, v12 quad_perm:[1,0,3,2] row_mask:0xf bank_mask:0xf
  s_nop 1
  v_add_f32_dpp v10, v10, v10 quad_perm:[2,3,0,1] row_mask:0xf bank_mask:0xf
  v_add_f32_dpp v12, v12, v12 quad_perm:[2,3,0,1] row_mask:0xf bank_mask:0xf
  s_nop 1
  v_add_f32_dpp v10, v10, v10 row_half_mirror row_mask:0xf bank_mask:0xf
  v_add_f32_dpp v12, v12, v12 row_half_mirror row_mask:0xf bank_mask:0xf
  v_mul_f32 v10, 0x3b124925, v10
  v_mul_f32 v12, 0x3b124925, v12
  v_fma_f32 v12, -v10, v10, v12
  v_max_f32 v12, 0, v12
  v_cvt_pk_bf16_f32 v14, v10, v12
  v_lshlrev_b32 v16, 16, v14
  v_and_b32 v15, 0xffff0000, v14
  v_add_f32 v15, 0x3727c5ac, v15
  v_cvt_pk_bf16_f32 v15, v15, v15
  v_and_b32 v15, 0xffff0000, v15
  v_sqrt_f32 v15, v15
  s_nop 0
  v_cvt_pk_bf16_f32 v15, v15, v15
  v_and_b32 v15, 0xffff0000, v15
  v_rcp_f32 v17, v15
  v_and_b32 v18, 7, v0
  v_cmp_eq_u32 vcc, 0, v18
HOP48:
  s_cbranch_execz HOP64
  s_nop 0
  s_and_saveexec_b64 s[74:75], vcc
  buffer_store_dwordx2 v[16:17], v252, s[40:43], 0 offen sc1
  s_mov_b64 exec, s[74:75]
  s_cmp_lt_u32 s66, 28
  s_cbranch_scc0 L_h7a
  s_cmp_lt_u32 s64, 16
  s_cbranch_scc0 L_h7wd
  s_mul_i32 s53, s64, 25088
  s_mov_b32 m0, 138240
  s_add_u32 s54, s53, 0
  buffer_load_dwordx4 v8, s[24:27], s54 offen lds
  s_mov_b32 m0, 139264
  s_add_u32 s54, s53, 7168
  buffer_load_dwordx4 v8, s[24:27], s54 offen lds
  s_mov_b32 m0, 140288
  s_add_u32 s54, s53, 14336
  buffer_load_dwordx4 v8, s[24:27], s54 offen lds
  s_mov_b32 m0, 141312
  s_add_u32 s54, s53, 21504
  buffer_load_dwordx4 v8, s[24:27], s54 offen lds
  s_branch L_h7we
L_h7wd:
  s_sub_u32 s53, s64, 16
  s_mul_i32 s53, s53, 28672
  s_mov_b32 m0, 138240
  s_add_u32 s54, s53, 0
  buffer_load_dwordx4 v8, s[28:31], s54 offen lds
  s_mov_b32 m0, 139264
  s_add_u32 s54, s53, 7168
  buffer_load_dwordx4 v8, s[28:31], s54 offen lds
  s_mov_b32 m0, 140288
  s_add_u32 s54, s53, 14336
  buffer_load_dwordx4 v8, s[28:31], s54 offen lds
  s_mov_b32 m0, 141312
  s_add_u32 s54, s53, 21504
  buffer_load_dwordx4 v8, s[28:31], s54 offen lds
L_h7we:
HOP49:
  s_cbranch_execz HOP65
  s_add_u32 s53, s64, 16
  s_mul_i32 s53, s53, 28672
  s_mov_b32 m0, 142336
  s_add_u32 s54, s53, 0
  buffer_load_dwordx4 v8, s[28:31], s54 offen lds
  s_mov_b32 m0, 143360
  s_add_u32 s54, s53, 7168
  buffer_load_dwordx4 v8, s[28:31], s54 offen lds
  s_mov_b32 m0, 144384
  s_add_u32 s54, s53, 14336
  buffer_load_dwordx4 v8, s[28:31], s54 offen lds
  s_mov_b32 m0, 145408
  s_add_u32 s54, s53, 21504
  buffer_load_dwordx4 v8, s[28:31], s54 offen lds
  s_mov_b32 m0, 146432
  s_add_u32 s54, s53, 917504
  buffer_load_dwordx4 v8, s[28:31], s54 offen lds
  s_mov_b32 m0, 147456
  s_add_u32 s54, s53, 924672
  buffer_load_dwordx4 v8, s[28:31], s54 offen lds
  s_mov_b32 m0, 148480
  s_add_u32 s54, s53, 931840
  buffer_load_dwordx4 v8, s[28:31], s54 offen lds
  s_mov_b32 m0, 149504
  s_add_u32 s54, s53, 939008
  buffer_load_dwordx4 v8, s[28:31], s54 offen lds
  v_lshrrev_b32 v1, 4, v0
  v_bfe_u32 v4, v0, 2, 2
  v_and_b32 v5, 3, v0
  v_lshlrev_b32 v5, 3, v5
  v_lshlrev_b32 v6, 2, v1
  v_add_u32 v6, v6, v4
  v_bfe_u32 v7, v6, 1, 2
  v_lshlrev_b32 v6, 7, v6
HOP50:
  s_cbranch_execz HOP66
  v_add3_u32 v6, v6, v5, 0
  v_add_u32 v6, 138240, v6
  v_xor_b32 v9, 0, v7
  v_lshlrev_b32 v9, 5, v9
  v_add_u32 v24, v6, v9
  v_xor_b32 v9, 1, v7
  v_lshlrev_b32 v9, 5, v9
  v_add_u32 v25, v6, v9
  v_xor_b32 v9, 2, v7
  v_lshlrev_b32 v9, 5, v9
  v_add_u32 v26, v6, v9
  v_xor_b32 v9, 3, v7
  v_lshlrev_b32 v9, 5, v9
  v_add_u32 v27, v6, v9
  s_mul_i32 s53, s65, 72
  s_add_u32 s53, s53, s64
  s_lshl_b32 s53, s53, 12
  s_add_u32 s53, s53, 9437184
  v_lshlrev_b32 v12, 4, v0
  s_barrier
  s_barrier
  s_waitcnt vmcnt(0)
  s_barrier
  ds_read_b64_tr_b16 v[64:65], v24 offset:0
  ds_read_b64_tr_b16 v[66:67], v24 offset:2048
  ds_read_b64_tr_b16 v[68:69], v25 offset:0
  ds_read_b64_tr_b16 v[70:71], v25 offset:2048
  ds_read_b64_tr_b16 v[72:73], v26 offset:0
  ds_read_b64_tr_b16 v[74:75], v26 offset:2048
  ds_read_b64_tr_b16 v[76:77], v27 offset:0
  ds_read_b64_tr_b16 v[78:79], v27 offset:2048
  ds_read_b64_tr_b16 v[80:81], v24 offset:4096
  ds_read_b64_tr_b16 v[82:83], v24 offset:6144
  ds_read_b64_tr_b16 v[84:85], v25 offset:4096
  ds_read_b64_tr_b16 v[86:87], v25 offset:6144
  ds_read_b64_tr_b16 v[88:89], v26 offset:4096
  ds_read_b64_tr_b16 v[90:91], v26 offset:6144
  ds_read_b64_tr_b16 v[92:93], v27 offset:4096
  ds_read_b64_tr_b16 v[94:95], v27 offset:6144
  ds_read_b64_tr_b16 v[96:97], v24 offset:8192
HOP51:
  s_cbranch_execz HOP67
  ds_read_b64_tr_b16 v[98:99], v24 offset:10240
  ds_read_b64_tr_b16 v[100:101], v25 offset:8192
  ds_read_b64_tr_b16 v[102:103], v25 offset:10240
  ds_read_b64_tr_b16 v[104:105], v26 offset:8192
  ds_read_b64_tr_b16 v[106:107], v26 offset:10240
  ds_read_b64_tr_b16 v[108:109], v27 offset:8192
  ds_read_b64_tr_b16 v[110:111], v27 offset:10240
  s_waitcnt lgkmcnt(0)
  s_add_u32 s54, s53, 0
  buffer_store_dwordx4 v[64:67], v12, s[40:43], s54 offen offset:0 sc1
  buffer_store_dwordx4 v[68:71], v12, s[40:43], s54 offen offset:1024 sc1
  buffer_store_dwordx4 v[72:75], v12, s[40:43], s54 offen offset:2048 sc1
  buffer_store_dwordx4 v[76:79], v12, s[40:43], s54 offen offset:3072 sc1
  s_add_u32 s54, s53, 131072
  buffer_store_dwordx4 v[80:83], v12, s[40:43], s54 offen offset:0 sc1
  buffer_store_dwordx4 v[84:87], v12, s[40:43], s54 offen offset:1024 sc1
  buffer_store_dwordx4 v[88:91], v12, s[40:43], s54 offen offset:2048 sc1
  buffer_store_dwordx4 v[92:95], v12, s[40:43], s54 offen offset:3072 sc1
  s_cmp_lt_u32 s64, 8
  s_cbranch_scc0 L_h7d
  s_add_u32 s54, s53, 262144
  buffer_store_dwordx4 v[96:99], v12, s[40:43], s54 offen offset:0 sc1
  buffer_store_dwordx4 v[100:103], v12, s[40:43], s54 offen offset:1024 sc1
  buffer_store_dwordx4 v[104:107], v12, s[40:43], s54 offen offset:2048 sc1
  buffer_store_dwordx4 v[108:111], v12, s[40:43], s54 offen offset:3072 sc1
  s_branch L_h7d
L_h7a:
  s_barrier
  s_barrier
  s_waitcnt vmcnt(0)
  s_barrier
L_h7d:
  v_min_u32 v1, 13, v0
  v_lshlrev_b32 v1, 4, v1
  v_add_u32 v1, s46, v1
  v_lshlrev_b32 v1, 7, v1
  v_add_u32 v22, 11993088, v1
  s_barrier
  s_barrier
  s_waitcnt vmcnt(0)
HOP52:
  s_cbranch_execz HOP68
  s_barrier
  v_mov_b32 v1, 152960
  ds_read_b32 v1, v1
  s_waitcnt lgkmcnt(0)
  v_readfirstlane_b32 s67, v1
  s_lshl_b32 s53, s45, 4
  s_add_u32 s53, s53, s46
  s_lshl_b32 s53, s53, 7
  s_add_u32 s53, s53, 11993092
  v_mov_b32 v1, s53
  v_mov_b32 v2, s67
  v_cmp_eq_u32 vcc, 0, v0
  s_nop 0
  s_and_saveexec_b64 s[74:75], vcc
  buffer_store_dword v2, v1, s[40:43], 0 offen sc1
  s_mov_b64 exec, s[74:75]
  s_barrier
  s_barrier
  s_barrier
  s_barrier
  buffer_load_dword v4, v22, s[40:43], 0 offen sc1
  s_barrier
  s_barrier
  s_mov_b32 s53, 0
L_pc:
  s_waitcnt vmcnt(0)
  v_cmp_eq_u32 vcc, s67, v4
  s_add_u32 s53, s53, 1
  s_cmp_eq_u64 vcc, exec
  s_cbranch_scc1 L_pcd
  s_sleep 4
  buffer_load_dword v4, v22, s[40:43], 0 offen sc1
  s_cmp_lt_u32 s53, 0x8000
  s_cbranch_scc1 L_pc
L_pcd:
  s_mul_i32 s55, s46, 8960
  s_add_u32 s55, s55, 11534336
  v_lshlrev_b32 v20, 4, v0
  s_add_u32 s56, s55, 0
  buffer_load_dwordx4 v[64:67], v20, s[40:43], s56 offen sc1
  s_add_u32 s56, s55, 1280
  buffer_load_dwordx4 v[68:71], v20, s[40:43], s56 offen sc1
  s_add_u32 s56, s55, 2560
  buffer_load_dwordx4 v[72:75], v20, s[40:43], s56 offen sc1
  s_add_u32 s56, s55, 3840
  buffer_load_dwordx4 v[76:79], v20, s[40:43], s56 offen sc1
HOP53:
  s_cbranch_execz HOP69
  s_barrier
  s_add_u32 s56, s55, 5120
  buffer_load_dwordx4 v[80:83], v20, s[40:43], s56 offen sc1
  s_add_u32 s56, s55, 6400
  buffer_load_dwordx4 v[84:87], v20, s[40:43], s56 offen sc1
  s_add_u32 s56, s55, 7680
  buffer_load_dwordx4 v[88:91], v20, s[40:43], s56 offen sc1
  s_barrier
  s_barrier
  s_waitcnt vmcnt(0)
  v_pk_add_f32 v[64:65], v[64:65], v[80:81]
  v_pk_add_f32 v[66:67], v[66:67], v[82:83]
  v_pk_add_f32 v[68:69], v[68:69], v[84:85]
  v_pk_add_f32 v[70:71], v[70:71], v[86:87]
  v_pk_add_f32 v[72:73], v[72:73], v[88:89]
  v_pk_add_f32 v[74:75], v[74:75], v[90:91]
  v_pk_add_f32 v[64:65], v[64:65], v[76:77]
  v_pk_add_f32 v[66:67], v[66:67], v[78:79]
  v_pk_add_f32 v[68:69], v[68:69], v[72:73]
  v_pk_add_f32 v[70:71], v[70:71], v[74:75]
  v_pk_add_f32 v[64:65], v[64:65], v[68:69]
  v_pk_add_f32 v[66:67], v[66:67], v[70:71]
  v_add_u32 v20, 151680, v20
  ds_write_b128 v20, v[64:67]
  s_waitcnt lgkmcnt(0)
  s_branch L_tail_help
L_cmpQ:
  v_mul_u32_u24 v26, 320, v25
  s_mul_i32 s53, s71, 160
  v_add3_u32 v26, v26, v22, s53
  v_lshlrev_b32 v28, 5, v24
  s_cmp_eq_u32 s71, 0
  s_cselect_b32 s53, 1, -1
  v_mul_lo_u32 v28, v28, s53
  v_add_u32 v5, v26, v28
  v_sub_u32 v6, v26, v28
  s_mov_b32 s72, 0
  s_mov_b32 s76, 18432
  s_mov_b32 s77, -36864
  s_mov_b32 s80, 20736
  s_mov_b32 s79, 20736
  s_mov_b32 s81, 4294925312
  s_barrier
  ds_read_b128 v[12:15], v1 offset:0
  ds_read_b128 v[16:19], v1 offset:2048
  ds_read_b128 v[20:23], v1 offset:4096
  ds_read_b128 v[24:27], v1 offset:6144
  ds_read_b64_tr_b16 v[44:45], v5 offset:0
  ds_read_b64_tr_b16 v[46:47], v5 offset:1280
  ds_read_b64_tr_b16 v[48:49], v5 offset:10272
  ds_read_b64_tr_b16 v[50:51], v5 offset:11552
  ds_read_b64_tr_b16 v[52:53], v6 offset:32
  ds_read_b64_tr_b16 v[54:55], v6 offset:1312
  ds_read_b64_tr_b16 v[56:57], v6 offset:10304
  ds_read_b64_tr_b16 v[58:59], v6 offset:11584
  ds_read_b64_tr_b16 v[60:61], v5 offset:64
  ds_read_b64_tr_b16 v[62:63], v5 offset:1344
  ds_read_b64_tr_b16 v[64:65], v5 offset:10336
  ds_read_b64_tr_b16 v[66:67], v5 offset:11616
  ds_read_b64_tr_b16 v[68:69], v6 offset:96
  ds_read_b64_tr_b16 v[70:71], v6 offset:1376
  ds_read_b64_tr_b16 v[72:73], v6 offset:10368
  ds_read_b64_tr_b16 v[74:75], v6 offset:11648
  ds_read_b64_tr_b16 v[76:77], v5 offset:128
  ds_read_b64_tr_b16 v[78:79], v5 offset:1408
L_clQ:
  s_waitcnt lgkmcnt(12)
  v_mfma_f32_16x16x32_bf16 v[96:99], v[44:47], v[12:15], v[96:99]
  ds_read_b64_tr_b16 v[80:81], v5 offset:10400
  v_mfma_f32_16x16x32_bf16 v[100:103], v[44:47], v[16:19], v[100:103]
  ds_read_b64_tr_b16 v[82:83], v5 offset:11680
  v_mfma_f32_16x16x32_bf16 v[104:107], v[44:47], v[20:23], v[104:107]
  v_mfma_f32_16x16x32_bf16 v[108:111], v[44:47], v[24:27], v[108:111]
  v_add_u32 v5, s80, v5
  v_mfma_f32_16x16x32_bf16 v[112:115], v[48:51], v[12:15], v[112:115]
  v_add_u32 v6, s80, v6
  v_mfma_f32_16x16x32_bf16 v[116:119], v[48:51], v[16:19], v[116:119]
  v_mfma_f32_16x16x32_bf16 v[120:123], v[48:51], v[20:23], v[120:123]
  v_mfma_f32_16x16x32_bf16 v[124:127], v[48:51], v[24:27], v[124:127]
  v_mfma_f32_16x16x32_bf16 v[128:131], v[52:55], v[12:15], v[128:131]
  v_mfma_f32_16x16x32_bf16 v[132:135], v[52:55], v[16:19], v[132:135]
  v_mfma_f32_16x16x32_bf16 v[136:139], v[52:55], v[20:23], v[136:139]
  v_mfma_f32_16x16x32_bf16 v[140:143], v[52:55], v[24:27], v[140:143]
  s_waitcnt lgkmcnt(0)
  s_barrier
  v_mfma_f32_16x16x32_bf16 v[144:147], v[56:59], v[12:15], v[144:147]
  ds_read_b128 v[28:31], v2 offset:0
  v_mfma_f32_16x16x32_bf16 v[148:151], v[56:59], v[16:19], v[148:151]
  ds_read_b128 v[32:35], v2 offset:2048
  v_mfma_f32_16x16x32_bf16 v[152:155], v[56:59], v[20:23], v[152:155]
  ds_read_b128 v[36:39], v2 offset:4096
  v_mfma_f32_16x16x32_bf16 v[156:159], v[56:59], v[24:27], v[156:159]
  ds_read_b128 v[40:43], v2 offset:6144
  v_mfma_f32_16x16x32_bf16 v[160:163], v[60:63], v[12:15], v[160:163]
  ds_read_b64_tr_b16 v[44:45], v5 offset:0
  v_mfma_f32_16x16x32_bf16 v[164:167], v[60:63], v[16:19], v[164:167]
  ds_read_b64_tr_b16 v[46:47], v5 offset:1280
  v_mfma_f32_16x16x32_bf16 v[168:171], v[60:63], v[20:23], v[168:171]
  ds_read_b64_tr_b16 v[48:49], v5 offset:10272
  v_mfma_f32_16x16x32_bf16 v[172:175], v[60:63], v[24:27], v[172:175]
  ds_read_b64_tr_b16 v[50:51], v5 offset:11552
  v_mfma_f32_16x16x32_bf16 v[176:179], v[64:67], v[12:15], v[176:179]
  ds_read_b64_tr_b16 v[52:53], v6 offset:32
  v_mfma_f32_16x16x32_bf16 v[180:183], v[64:67], v[16:19], v[180:183]
  ds_read_b64_tr_b16 v[54:55], v6 offset:1312
  v_mfma_f32_16x16x32_bf16 v[184:187], v[64:67], v[20:23], v[184:187]
  s_add_u32 s72, s72, 1
  v_mfma_f32_16x16x32_bf16 v[188:191], v[64:67], v[24:27], v[188:191]
  s_cmp_eq_u32 s72, 3
  v_mfma_f32_16x16x32_bf16 v[192:195], v[68:71], v[12:15], v[192:195]
  s_cselect_b32 s73, s77, s76
  v_mfma_f32_16x16x32_bf16 v[196:199], v[68:71], v[16:19], v[196:199]
  s_cselect_b32 s72, 0, s72
  v_mfma_f32_16x16x32_bf16 v[200:203], v[68:71], v[20:23], v[200:203]
  ds_read_b64_tr_b16 v[56:57], v6 offset:10304
  v_mfma_f32_16x16x32_bf16 v[204:207], v[68:71], v[24:27], v[204:207]
  ds_read_b64_tr_b16 v[58:59], v6 offset:11584
  v_mfma_f32_16x16x32_bf16 v[208:211], v[72:75], v[12:15], v[208:211]
  ds_read_b64_tr_b16 v[60:61], v5 offset:64
  v_mfma_f32_16x16x32_bf16 v[212:215], v[72:75], v[16:19], v[212:215]
  ds_read_b64_tr_b16 v[62:63], v5 offset:1344
  v_mfma_f32_16x16x32_bf16 v[216:219], v[72:75], v[20:23], v[216:219]
  ds_read_b64_tr_b16 v[64:65], v5 offset:10336
  v_mfma_f32_16x16x32_bf16 v[220:223], v[72:75], v[24:27], v[220:223]
  ds_read_b64_tr_b16 v[66:67], v5 offset:11616
  v_mfma_f32_16x16x32_bf16 v[224:227], v[76:79], v[12:15], v[224:227]
  ds_read_b64_tr_b16 v[68:69], v6 offset:96
  v_mfma_f32_16x16x32_bf16 v[228:231], v[76:79], v[16:19], v[228:231]
  ds_read_b64_tr_b16 v[70:71], v6 offset:1376
  v_mfma_f32_16x16x32_bf16 v[232:235], v[76:79], v[20:23], v[232:235]
  ds_read_b64_tr_b16 v[72:73], v6 offset:10368
  v_mfma_f32_16x16x32_bf16 v[236:239], v[76:79], v[24:27], v[236:239]
  ds_read_b64_tr_b16 v[74:75], v6 offset:11648
  v_mfma_f32_16x16x32_bf16 v[240:243], v[80:83], v[12:15], v[240:243]
  ds_read_b64_tr_b16 v[76:77], v5 offset:128
  v_mfma_f32_16x16x32_bf16 v[244:247], v[80:83], v[16:19], v[244:247]
  ds_read_b64_tr_b16 v[78:79], v5 offset:1408
  v_mfma_f32_16x16x32_bf16 v[248:251], v[80:83], v[20:23], v[248:251]
  v_mfma_f32_16x16x32_bf16 v[252:255], v[80:83], v[24:27], v[252:255]
  s_waitcnt lgkmcnt(12)
  v_mfma_f32_16x16x32_bf16 v[96:99], v[44:47], v[28:31], v[96:99]
  ds_read_b64_tr_b16 v[80:81], v5 offset:10400
  v_mfma_f32_16x16x32_bf16 v[100:103], v[44:47], v[32:35], v[100:103]
  ds_read_b64_tr_b16 v[82:83], v5 offset:11680
  v_mfma_f32_16x16x32_bf16 v[104:107], v[44:47], v[36:39], v[104:107]
  v_mfma_f32_16x16x32_bf16 v[108:111], v[44:47], v[40:43], v[108:111]
  v_add_u32 v5, s79, v5
  v_mfma_f32_16x16x32_bf16 v[112:115], v[48:51], v[28:31], v[112:115]
  v_add_u32 v6, s79, v6
  v_mfma_f32_16x16x32_bf16 v[116:119], v[48:51], v[32:35], v[116:119]
  v_add_u32 v1, s73, v1
  v_mfma_f32_16x16x32_bf16 v[120:123], v[48:51], v[36:39], v[120:123]
  v_add_u32 v2, s73, v2
  v_mfma_f32_16x16x32_bf16 v[124:127], v[48:51], v[40:43], v[124:127]
  v_mfma_f32_16x16x32_bf16 v[128:131], v[52:55], v[28:31], v[128:131]
  v_mfma_f32_16x16x32_bf16 v[132:135], v[52:55], v[32:35], v[132:135]
  v_mfma_f32_16x16x32_bf16 v[136:139], v[52:55], v[36:39], v[136:139]
  v_mfma_f32_16x16x32_bf16 v[140:143], v[52:55], v[40:43], v[140:143]
  s_waitcnt lgkmcnt(0)
  s_barrier
  v_mfma_f32_16x16x32_bf16 v[144:147], v[56:59], v[28:31], v[144:147]
  ds_read_b128 v[12:15], v1 offset:0
  v_mfma_f32_16x16x32_bf16 v[148:151], v[56:59], v[32:35], v[148:151]
  ds_read_b128 v[16:19], v1 offset:2048
  v_mfma_f32_16x16x32_bf16 v[152:155], v[56:59], v[36:39], v[152:155]
  ds_read_b128 v[20:23], v1 offset:4096
  v_mfma_f32_16x16x32_bf16 v[156:159], v[56:59], v[40:43], v[156:159]
  ds_read_b128 v[24:27], v1 offset:6144
  v_mfma_f32_16x16x32_bf16 v[160:163], v[60:63], v[28:31], v[160:163]
  ds_read_b64_tr_b16 v[44:45], v5 offset:0
  v_mfma_f32_16x16x32_bf16 v[164:167], v[60:63], v[32:35], v[164:167]
  ds_read_b64_tr_b16 v[46:47], v5 offset:1280
  v_mfma_f32_16x16x32_bf16 v[168:171], v[60:63], v[36:39], v[168:171]
  ds_read_b64_tr_b16 v[48:49], v5 offset:10272
  v_mfma_f32_16x16x32_bf16 v[172:175], v[60:63], v[40:43], v[172:175]
  ds_read_b64_tr_b16 v[50:51], v5 offset:11552
  v_mfma_f32_16x16x32_bf16 v[176:179], v[64:67], v[28:31], v[176:179]
  ds_read_b64_tr_b16 v[52:53], v6 offset:32
  v_mfma_f32_16x16x32_bf16 v[180:183], v[64:67], v[32:35], v[180:183]
  ds_read_b64_tr_b16 v[54:55], v6 offset:1312
  v_mfma_f32_16x16x32_bf16 v[184:187], v[64:67], v[36:39], v[184:187]
  s_xor_b32 s79, s79, s81
  v_mfma_f32_16x16x32_bf16 v[188:191], v[64:67], v[40:43], v[188:191]
  ds_read_b64_tr_b16 v[56:57], v6 offset:10304
  v_mfma_f32_16x16x32_bf16 v[192:195], v[68:71], v[28:31], v[192:195]
  ds_read_b64_tr_b16 v[58:59], v6 offset:11584
  v_mfma_f32_16x16x32_bf16 v[196:199], v[68:71], v[32:35], v[196:199]
  ds_read_b64_tr_b16 v[60:61], v5 offset:64
  v_mfma_f32_16x16x32_bf16 v[200:203], v[68:71], v[36:39], v[200:203]
  ds_read_b64_tr_b16 v[62:63], v5 offset:1344
  v_mfma_f32_16x16x32_bf16 v[204:207], v[68:71], v[40:43], v[204:207]
  ds_read_b64_tr_b16 v[64:65], v5 offset:10336
  v_mfma_f32_16x16x32_bf16 v[208:211], v[72:75], v[28:31], v[208:211]
  ds_read_b64_tr_b16 v[66:67], v5 offset:11616
  v_mfma_f32_16x16x32_bf16 v[212:215], v[72:75], v[32:35], v[212:215]
  ds_read_b64_tr_b16 v[68:69], v6 offset:96
  v_mfma_f32_16x16x32_bf16 v[216:219], v[72:75], v[36:39], v[216:219]
  ds_read_b64_tr_b16 v[70:71], v6 offset:1376
  v_mfma_f32_16x16x32_bf16 v[220:223], v[72:75], v[40:43], v[220:223]
  v_mfma_f32_16x16x32_bf16 v[224:227], v[76:79], v[28:31], v[224:227]
  ds_read_b64_tr_b16 v[72:73], v6 offset:10368
  v_mfma_f32_16x16x32_bf16 v[228:231], v[76:79], v[32:35], v[228:231]
  ds_read_b64_tr_b16 v[74:75], v6 offset:11648
  v_mfma_f32_16x16x32_bf16 v[232:235], v[76:79], v[36:39], v[232:235]
  v_mfma_f32_16x16x32_bf16 v[236:239], v[76:79], v[40:43], v[236:239]
  v_mfma_f32_16x16x32_bf16 v[240:243], v[80:83], v[28:31], v[240:243]
  ds_read_b64_tr_b16 v[76:77], v5 offset:128
  v_mfma_f32_16x16x32_bf16 v[244:247], v[80:83], v[32:35], v[244:247]
  ds_read_b64_tr_b16 v[78:79], v5 offset:1408
  v_mfma_f32_16x16x32_bf16 v[248:251], v[80:83], v[36:39], v[248:251]
  v_mfma_f32_16x16x32_bf16 v[252:255], v[80:83], v[40:43], v[252:255]
  s_add_u32 s69, s69, 2
  s_cmp_eq_u32 s69, 14
  s_cbranch_scc0 L_clQ
  s_waitcnt lgkmcnt(0)
  s_barrier
HOP54:
  s_cbranch_execz HOP70
  v_mov_b32 v1, 152960
  ds_read_b32 v1, v1
  v_and_b32 v12, 15, v0
  s_lshl_b32 s53, s70, 6
  s_add_u32 s53, s53, 16
  v_add_u32 v12, s53, v12
  v_lshlrev_b32 v12, 2, v12
  v_add_u32 v12, 150528, v12
  ds_read_b32 v2, v12 offset:0
  ds_read_b32 v6, v12 offset:576
  ds_read_b32 v3, v12 offset:64
  ds_read_b32 v7, v12 offset:640
  ds_read_b32 v4, v12 offset:128
  ds_read_b32 v8, v12 offset:704
  ds_read_b32 v5, v12 offset:192
  ds_read_b32 v9, v12 offset:768
  v_lshrrev_b32 v10, 4, v0
  v_lshlrev_b32 v10, 4, v10
  s_mul_i32 s53, s71, 640
  s_add_u32 s53, s53, 151680
  v_add_u32 v10, s53, v10
  v_lshlrev_b32 v11, 4, v0
  ds_read_b128 v[16:19], v10 offset:0
  ds_read_b128 v[20:23], v10 offset:64
  ds_read_b128 v[24:27], v10 offset:128
  ds_read_b128 v[28:31], v10 offset:192
  ds_read_b128 v[32:35], v10 offset:256
  ds_read_b128 v[36:39], v10 offset:320
  ds_read_b128 v[40:43], v10 offset:384
  ds_read_b128 v[44:47], v10 offset:448
  ds_read_b128 v[48:51], v10 offset:512
  ds_read_b128 v[52:55], v10 offset:576
  s_lshl_b32 s53, s45, 3
  s_lshl_b32 s54, s70, 2
  s_add_u32 s53, s53, s54
  s_mul_i32 s53, s53, 72
HOP55:
  s_cbranch_execz HOP71
  s_mul_i32 s54, s47, 5
  s_add_u32 s53, s53, s54
  s_add_u32 s53, s53, 32
  s_lshl_b32 s72, s53, 10
  v_lshlrev_b32 v12, 3, v0
  s_lshl_b32 s53, s71, 9
  v_add_u32 v12, s53, v12
  s_waitcnt lgkmcnt(0)
  v_readfirstlane_b32 s67, v1
  s_cmp_eq_u32 s71, 0
  s_cbranch_scc0 L_qh1
  v_pk_mul_f32 v[6:7], v[6:7], v[6:7]
  v_pk_mul_f32 v[8:9], v[8:9], v[8:9]
  v_pk_fma_f32 v[96:97], v[2:3], v[16:17], v[96:97] op_sel:[0,0,0] op_sel_hi:[0,1,1] neg_lo:[1,0,0] neg_hi:[1,0,0]
  v_pk_fma_f32 v[98:99], v[2:3], v[18:19], v[98:99] op_sel:[0,0,0] op_sel_hi:[0,1,1] neg_lo:[1,0,0] neg_hi:[1,0,0]
  v_pk_fma_f32 v[112:113], v[2:3], v[20:21], v[112:113] op_sel:[0,0,0] op_sel_hi:[0,1,1] neg_lo:[1,0,0] neg_hi:[1,0,0]
  v_pk_fma_f32 v[114:115], v[2:3], v[22:23], v[114:115] op_sel:[0,0,0] op_sel_hi:[0,1,1] neg_lo:[1,0,0] neg_hi:[1,0,0]
  v_pk_mul_f32 v[96:97], v[96:97], v[112:113]
  v_pk_mul_f32 v[98:99], v[98:99], v[114:115]
  v_pk_mul_f32 v[96:97], v[6:7], v[96:97] op_sel:[0,0] op_sel_hi:[0,1]
  v_pk_mul_f32 v[98:99], v[6:7], v[98:99] op_sel:[0,0] op_sel_hi:[0,1]
  v_cvt_pk_bf16_f32 v56, v96, v97
  v_cvt_pk_bf16_f32 v57, v98, v99
  v_pk_fma_f32 v[128:129], v[2:3], v[24:25], v[128:129] op_sel:[0,0,0] op_sel_hi:[0,1,1] neg_lo:[1,0,0] neg_hi:[1,0,0]
  v_pk_fma_f32 v[130:131], v[2:3], v[26:27], v[130:131] op_sel:[0,0,0] op_sel_hi:[0,1,1] neg_lo:[1,0,0] neg_hi:[1,0,0]
  v_pk_fma_f32 v[144:145], v[2:3], v[28:29], v[144:145] op_sel:[0,0,0] op_sel_hi:[0,1,1] neg_lo:[1,0,0] neg_hi:[1,0,0]
  v_pk_fma_f32 v[146:147], v[2:3], v[30:31], v[146:147] op_sel:[0,0,0] op_sel_hi:[0,1,1] neg_lo:[1,0,0] neg_hi:[1,0,0]
  v_pk_mul_f32 v[128:129], v[128:129], v[144:145]
  v_pk_mul_f32 v[130:131], v[130:131], v[146:147]
  v_pk_mul_f32 v[128:129], v[6:7], v[128:129] op_sel:[0,0] op_sel_hi:[0,1]
  v_pk_mul_f32 v[130:131], v[6:7], v[130:131] op_sel:[0,0] op_sel_hi:[0,1]
  v_cvt_pk_bf16_f32 v58, v128, v129
  v_cvt_pk_bf16_f32 v59, v130, v131
  s_add_u32 s56, s72, 0
  buffer_store_dwordx4 v[56:59], v11, s[40:43], s56 offen sc1
  v_pk_fma_f32 v[160:161], v[2:3], v[32:33], v[160:161] op_sel:[0,0,0] op_sel_hi:[0,1,1] neg_lo:[1,0,0] neg_hi:[1,0,0]
HOP56:
  s_cbranch_execz HOP72
  v_pk_fma_f32 v[162:163], v[2:3], v[34:35], v[162:163] op_sel:[0,0,0] op_sel_hi:[0,1,1] neg_lo:[1,0,0] neg_hi:[1,0,0]
  v_pk_fma_f32 v[176:177], v[2:3], v[36:37], v[176:177] op_sel:[0,0,0] op_sel_hi:[0,1,1] neg_lo:[1,0,0] neg_hi:[1,0,0]
  v_pk_fma_f32 v[178:179], v[2:3], v[38:39], v[178:179] op_sel:[0,0,0] op_sel_hi:[0,1,1] neg_lo:[1,0,0] neg_hi:[1,0,0]
  v_pk_mul_f32 v[160:161], v[160:161], v[176:177]
  v_pk_mul_f32 v[162:163], v[162:163], v[178:179]
  v_pk_mul_f32 v[160:161], v[6:7], v[160:161] op_sel:[0,0] op_sel_hi:[0,1]
  v_pk_mul_f32 v[162:163], v[6:7], v[162:163] op_sel:[0,0] op_sel_hi:[0,1]
  v_cvt_pk_bf16_f32 v60, v160, v161
  v_cvt_pk_bf16_f32 v61, v162, v163
  v_pk_fma_f32 v[192:193], v[2:3], v[40:41], v[192:193] op_sel:[0,0,0] op_sel_hi:[0,1,1] neg_lo:[1,0,0] neg_hi:[1,0,0]
  v_pk_fma_f32 v[194:195], v[2:3], v[42:43], v[194:195] op_sel:[0,0,0] op_sel_hi:[0,1,1] neg_lo:[1,0,0] neg_hi:[1,0,0]
  v_pk_fma_f32 v[208:209], v[2:3], v[44:45], v[208:209] op_sel:[0,0,0] op_sel_hi:[0,1,1] neg_lo:[1,0,0] neg_hi:[1,0,0]
  v_pk_fma_f32 v[210:211], v[2:3], v[46:47], v[210:211] op_sel:[0,0,0] op_sel_hi:[0,1,1] neg_lo:[1,0,0] neg_hi:[1,0,0]
  v_pk_mul_f32 v[192:193], v[192:193], v[208:209]
  v_pk_mul_f32 v[194:195], v[194:195], v[210:211]
  v_pk_mul_f32 v[192:193], v[6:7], v[192:193] op_sel:[0,0] op_sel_hi:[0,1]
  v_pk_mul_f32 v[194:195], v[6:7], v[194:195] op_sel:[0,0] op_sel_hi:[0,1]
  v_cvt_pk_bf16_f32 v62, v192, v193
  v_cvt_pk_bf16_f32 v63, v194, v195
  s_add_u32 s56, s72, 1024
  buffer_store_dwordx4 v[60:63], v11, s[40:43], s56 offen sc1
  v_pk_fma_f32 v[224:225], v[2:3], v[48:49], v[224:225] op_sel:[0,0,0] op_sel_hi:[0,1,1] neg_lo:[1,0,0] neg_hi:[1,0,0]
  v_pk_fma_f32 v[226:227], v[2:3], v[50:51], v[226:227] op_sel:[0,0,0] op_sel_hi:[0,1,1] neg_lo:[1,0,0] neg_hi:[1,0,0]
  v_pk_fma_f32 v[240:241], v[2:3], v[52:53], v[240:241] op_sel:[0,0,0] op_sel_hi:[0,1,1] neg_lo:[1,0,0] neg_hi:[1,0,0]
  v_pk_fma_f32 v[242:243], v[2:3], v[54:55], v[242:243] op_sel:[0,0,0] op_sel_hi:[0,1,1] neg_lo:[1,0,0] neg_hi:[1,0,0]
  v_pk_mul_f32 v[224:225], v[224:225], v[240:241]
  v_pk_mul_f32 v[226:227], v[226:227], v[242:243]
  v_pk_mul_f32 v[224:225], v[6:7], v[224:225] op_sel:[0,0] op_sel_hi:[0,1]
  v_pk_mul_f32 v[226:227], v[6:7], v[226:227] op_sel:[0,0] op_sel_hi:[0,1]
  v_cvt_pk_bf16_f32 v64, v224, v225
HOP57:
  s_cbranch_execz HOP73
  v_cvt_pk_bf16_f32 v65, v226, v227
  s_add_u32 s56, s72, 2048
  buffer_store_dwordx2 v[64:65], v12, s[40:43], s56 offen sc1
  v_pk_fma_f32 v[100:101], v[2:3], v[16:17], v[100:101] op_sel:[1,0,0] op_sel_hi:[1,1,1] neg_lo:[1,0,0] neg_hi:[1,0,0]
  v_pk_fma_f32 v[102:103], v[2:3], v[18:19], v[102:103] op_sel:[1,0,0] op_sel_hi:[1,1,1] neg_lo:[1,0,0] neg_hi:[1,0,0]
  v_pk_fma_f32 v[116:117], v[2:3], v[20:21], v[116:117] op_sel:[1,0,0] op_sel_hi:[1,1,1] neg_lo:[1,0,0] neg_hi:[1,0,0]
  v_pk_fma_f32 v[118:119], v[2:3], v[22:23], v[118:119] op_sel:[1,0,0] op_sel_hi:[1,1,1] neg_lo:[1,0,0] neg_hi:[1,0,0]
  v_pk_mul_f32 v[100:101], v[100:101], v[116:117]
  v_pk_mul_f32 v[102:103], v[102:103], v[118:119]
  v_pk_mul_f32 v[100:101], v[6:7], v[100:101] op_sel:[1,0] op_sel_hi:[1,1]
  v_pk_mul_f32 v[102:103], v[6:7], v[102:103] op_sel:[1,0] op_sel_hi:[1,1]
  v_cvt_pk_bf16_f32 v56, v100, v101
  v_cvt_pk_bf16_f32 v57, v102, v103
  v_pk_fma_f32 v[132:133], v[2:3], v[24:25], v[132:133] op_sel:[1,0,0] op_sel_hi:[1,1,1] neg_lo:[1,0,0] neg_hi:[1,0,0]
  v_pk_fma_f32 v[134:135], v[2:3], v[26:27], v[134:135] op_sel:[1,0,0] op_sel_hi:[1,1,1] neg_lo:[1,0,0] neg_hi:[1,0,0]
  v_pk_fma_f32 v[148:149], v[2:3], v[28:29], v[148:149] op_sel:[1,0,0] op_sel_hi:[1,1,1] neg_lo:[1,0,0] neg_hi:[1,0,0]
  v_pk_fma_f32 v[150:151], v[2:3], v[30:31], v[150:151] op_sel:[1,0,0] op_sel_hi:[1,1,1] neg_lo:[1,0,0] neg_hi:[1,0,0]
  v_pk_mul_f32 v[132:133], v[132:133], v[148:149]
  v_pk_mul_f32 v[134:135], v[134:135], v[150:151]
  v_pk_mul_f32 v[132:133], v[6:7], v[132:133] op_sel:[1,0] op_sel_hi:[1,1]
  v_pk_mul_f32 v[134:135], v[6:7], v[134:135] op_sel:[1,0] op_sel_hi:[1,1]
  v_cvt_pk_bf16_f32 v58, v132, v133
  v_cvt_pk_bf16_f32 v59, v134, v135
  s_add_u32 s56, s72, 73728
  buffer_store_dwordx4 v[56:59], v11, s[40:43], s56 offen sc1
  v_pk_fma_f32 v[164:165], v[2:3], v[32:33], v[164:165] op_sel:[1,0,0] op_sel_hi:[1,1,1] neg_lo:[1,0,0] neg_hi:[1,0,0]
  v_pk_fma_f32 v[166:167], v[2:3], v[34:35], v[166:167] op_sel:[1,0,0] op_sel_hi:[1,1,1] neg_lo:[1,0,0] neg_hi:[1,0,0]
  v_pk_fma_f32 v[180:181], v[2:3], v[36:37], v[180:181] op_sel:[1,0,0] op_sel_hi:[1,1,1] neg_lo:[1,0,0] neg_hi:[1,0,0]
  v_pk_fma_f32 v[182:183], v[2:3], v[38:39], v[182:183] op_sel:[1,0,0] op_sel_hi:[1,1,1] neg_lo:[1,0,0] neg_hi:[1,0,0]
  v_pk_mul_f32 v[164:165], v[164:165], v[180:181]
HOP58:
  s_cbranch_execz HOP74
  v_pk_mul_f32 v[166:167], v[166:167], v[182:183]
  v_pk_mul_f32 v[164:165], v[6:7], v[164:165] op_sel:[1,0] op_sel_hi:[1,1]
  v_pk_mul_f32 v[166:167], v[6:7], v[166:167] op_sel:[1,0] op_sel_hi:[1,1]
  v_cvt_pk_bf16_f32 v60, v164, v165
  v_cvt_pk_bf16_f32 v61, v166, v167
  v_pk_fma_f32 v[196:197], v[2:3], v[40:41], v[196:197] op_sel:[1,0,0] op_sel_hi:[1,1,1] neg_lo:[1,0,0] neg_hi:[1,0,0]
  v_pk_fma_f32 v[198:199], v[2:3], v[42:43], v[198:199] op_sel:[1,0,0] op_sel_hi:[1,1,1] neg_lo:[1,0,0] neg_hi:[1,0,0]
  v_pk_fma_f32 v[212:213], v[2:3], v[44:45], v[212:213] op_sel:[1,0,0] op_sel_hi:[1,1,1] neg_lo:[1,0,0] neg_hi:[1,0,0]
  v_pk_fma_f32 v[214:215], v[2:3], v[46:47], v[214:215] op_sel:[1,0,0] op_sel_hi:[1,1,1] neg_lo:[1,0,0] neg_hi:[1,0,0]
  v_pk_mul_f32 v[196:197], v[196:197], v[212:213]
  v_pk_mul_f32 v[198:199], v[198:199], v[214:215]
  v_pk_mul_f32 v[196:197], v[6:7], v[196:197] op_sel:[1,0] op_sel_hi:[1,1]
  v_pk_mul_f32 v[198:199], v[6:7], v[198:199] op_sel:[1,0] op_sel_hi:[1,1]
  v_cvt_pk_bf16_f32 v62, v196, v197
  v_cvt_pk_bf16_f32 v63, v198, v199
  s_add_u32 s56, s72, 74752
  buffer_store_dwordx4 v[60:63], v11, s[40:43], s56 offen sc1
  v_pk_fma_f32 v[228:229], v[2:3], v[48:49], v[228:229] op_sel:[1,0,0] op_sel_hi:[1,1,1] neg_lo:[1,0,0] neg_hi:[1,0,0]
  v_pk_fma_f32 v[230:231], v[2:3], v[50:51], v[230:231] op_sel:[1,0,0] op_sel_hi:[1,1,1] neg_lo:[1,0,0] neg_hi:[1,0,0]
  v_pk_fma_f32 v[244:245], v[2:3], v[52:53], v[244:245] op_sel:[1,0,0] op_sel_hi:[1,1,1] neg_lo:[1,0,0] neg_hi:[1,0,0]
  v_pk_fma_f32 v[246:247], v[2:3], v[54:55], v[246:247] op_sel:[1,0,0] op_sel_hi:[1,1,1] neg_lo:[1,0,0] neg_hi:[1,0,0]
  v_pk_mul_f32 v[228:229], v[228:229], v[244:245]
  v_pk_mul_f32 v[230:231], v[230:231], v[246:247]
  v_pk_mul_f32 v[228:229], v[6:7], v[228:229] op_sel:[1,0] op_sel_hi:[1,1]
  v_pk_mul_f32 v[230:231], v[6:7], v[230:231] op_sel:[1,0] op_sel_hi:[1,1]
  v_cvt_pk_bf16_f32 v66, v228, v229
  v_cvt_pk_bf16_f32 v67, v230, v231
  s_add_u32 s56, s72, 75776
  buffer_store_dwordx2 v[66:67], v12, s[40:43], s56 offen sc1
  v_pk_fma_f32 v[104:105], v[4:5], v[16:17], v[104:105] op_sel:[0,0,0] op_sel_hi:[0,1,1] neg_lo:[1,0,0] neg_hi:[1,0,0]
HOP59:
  s_cbranch_execz HOP75
  v_pk_fma_f32 v[106:107], v[4:5], v[18:19], v[106:107] op_sel:[0,0,0] op_sel_hi:[0,1,1] neg_lo:[1,0,0] neg_hi:[1,0,0]
  v_pk_fma_f32 v[120:121], v[4:5], v[20:21], v[120:121] op_sel:[0,0,0] op_sel_hi:[0,1,1] neg_lo:[1,0,0] neg_hi:[1,0,0]
  v_pk_fma_f32 v[122:123], v[4:5], v[22:23], v[122:123] op_sel:[0,0,0] op_sel_hi:[0,1,1] neg_lo:[1,0,0] neg_hi:[1,0,0]
  v_pk_mul_f32 v[104:105], v[104:105], v[120:121]
  v_pk_mul_f32 v[106:107], v[106:107], v[122:123]
  v_pk_mul_f32 v[104:105], v[8:9], v[104:105] op_sel:[0,0] op_sel_hi:[0,1]
  v_pk_mul_f32 v[106:107], v[8:9], v[106:107] op_sel:[0,0] op_sel_hi:[0,1]
  v_cvt_pk_bf16_f32 v56, v104, v105
  v_cvt_pk_bf16_f32 v57, v106, v107
  v_pk_fma_f32 v[136:137], v[4:5], v[24:25], v[136:137] op_sel:[0,0,0] op_sel_hi:[0,1,1] neg_lo:[1,0,0] neg_hi:[1,0,0]
  v_pk_fma_f32 v[138:139], v[4:5], v[26:27], v[138:139] op_sel:[0,0,0] op_sel_hi:[0,1,1] neg_lo:[1,0,0] neg_hi:[1,0,0]
  v_pk_fma_f32 v[152:153], v[4:5], v[28:29], v[152:153] op_sel:[0,0,0] op_sel_hi:[0,1,1] neg_lo:[1,0,0] neg_hi:[1,0,0]
  v_pk_fma_f32 v[154:155], v[4:5], v[30:31], v[154:155] op_sel:[0,0,0] op_sel_hi:[0,1,1] neg_lo:[1,0,0] neg_hi:[1,0,0]
  v_pk_mul_f32 v[136:137], v[136:137], v[152:153]
  v_pk_mul_f32 v[138:139], v[138:139], v[154:155]
  v_pk_mul_f32 v[136:137], v[8:9], v[136:137] op_sel:[0,0] op_sel_hi:[0,1]
  v_pk_mul_f32 v[138:139], v[8:9], v[138:139] op_sel:[0,0] op_sel_hi:[0,1]
  v_cvt_pk_bf16_f32 v58, v136, v137
  v_cvt_pk_bf16_f32 v59, v138, v139
  s_add_u32 s56, s72, 147456
  buffer_store_dwordx4 v[56:59], v11, s[40:43], s56 offen sc1
  v_pk_fma_f32 v[168:169], v[4:5], v[32:33], v[168:169] op_sel:[0,0,0] op_sel_hi:[0,1,1] neg_lo:[1,0,0] neg_hi:[1,0,0]
  v_pk_fma_f32 v[170:171], v[4:5], v[34:35], v[170:171] op_sel:[0,0,0] op_sel_hi:[0,1,1] neg_lo:[1,0,0] neg_hi:[1,0,0]
  v_pk_fma_f32 v[184:185], v[4:5], v[36:37], v[184:185] op_sel:[0,0,0] op_sel_hi:[0,1,1] neg_lo:[1,0,0] neg_hi:[1,0,0]
  v_pk_fma_f32 v[186:187], v[4:5], v[38:39], v[186:187] op_sel:[0,0,0] op_sel_hi:[0,1,1] neg_lo:[1,0,0] neg_hi:[1,0,0]
  v_pk_mul_f32 v[168:169], v[168:169], v[184:185]
  v_pk_mul_f32 v[170:171], v[170:171], v[186:187]
  v_pk_mul_f32 v[168:169], v[8:9], v[168:169] op_sel:[0,0] op_sel_hi:[0,1]
  v_pk_mul_f32 v[170:171], v[8:9], v[170:171] op_sel:[0,0] op_sel_hi:[0,1]
  v_cvt_pk_bf16_f32 v60, v168, v169
HOP60:
  s_cbranch_execz HOP76
  v_cvt_pk_bf16_f32 v61, v170, v171
  v_pk_fma_f32 v[200:201], v[4:5], v[40:41], v[200:201] op_sel:[0,0,0] op_sel_hi:[0,1,1] neg_lo:[1,0,0] neg_hi:[1,0,0]
  v_pk_fma_f32 v[202:203], v[4:5], v[42:43], v[202:203] op_sel:[0,0,0] op_sel_hi:[0,1,1] neg_lo:[1,0,0] neg_hi:[1,0,0]
  v_pk_fma_f32 v[216:217], v[4:5], v[44:45], v[216:217] op_sel:[0,0,0] op_sel_hi:[0,1,1] neg_lo:[1,0,0] neg_hi:[1,0,0]
  v_pk_fma_f32 v[218:219], v[4:5], v[46:47], v[218:219] op_sel:[0,0,0] op_sel_hi:[0,1,1] neg_lo:[1,0,0] neg_hi:[1,0,0]
  v_pk_mul_f32 v[200:201], v[200:201], v[216:217]
  v_pk_mul_f32 v[202:203], v[202:203], v[218:219]
  v_pk_mul_f32 v[200:201], v[8:9], v[200:201] op_sel:[0,0] op_sel_hi:[0,1]
  v_pk_mul_f32 v[202:203], v[8:9], v[202:203] op_sel:[0,0] op_sel_hi:[0,1]
  v_cvt_pk_bf16_f32 v62, v200, v201
  v_cvt_pk_bf16_f32 v63, v202, v203
  s_add_u32 s56, s72, 148480
  buffer_store_dwordx4 v[60:63], v11, s[40:43], s56 offen sc1
  v_pk_fma_f32 v[232:233], v[4:5], v[48:49], v[232:233] op_sel:[0,0,0] op_sel_hi:[0,1,1] neg_lo:[1,0,0] neg_hi:[1,0,0]
  v_pk_fma_f32 v[234:235], v[4:5], v[50:51], v[234:235] op_sel:[0,0,0] op_sel_hi:[0,1,1] neg_lo:[1,0,0] neg_hi:[1,0,0]
  v_pk_fma_f32 v[248:249], v[4:5], v[52:53], v[248:249] op_sel:[0,0,0] op_sel_hi:[0,1,1] neg_lo:[1,0,0] neg_hi:[1,0,0]
  v_pk_fma_f32 v[250:251], v[4:5], v[54:55], v[250:251] op_sel:[0,0,0] op_sel_hi:[0,1,1] neg_lo:[1,0,0] neg_hi:[1,0,0]
  v_pk_mul_f32 v[232:233], v[232:233], v[248:249]
  v_pk_mul_f32 v[234:235], v[234:235], v[250:251]
  v_pk_mul_f32 v[232:233], v[8:9], v[232:233] op_sel:[0,0] op_sel_hi:[0,1]
  v_pk_mul_f32 v[234:235], v[8:9], v[234:235] op_sel:[0,0] op_sel_hi:[0,1]
  v_cvt_pk_bf16_f32 v64, v232, v233
  v_cvt_pk_bf16_f32 v65, v234, v235
  s_add_u32 s56, s72, 149504
  buffer_store_dwordx2 v[64:65], v12, s[40:43], s56 offen sc1
  v_pk_fma_f32 v[108:109], v[4:5], v[16:17], v[108:109] op_sel:[1,0,0] op_sel_hi:[1,1,1] neg_lo:[1,0,0] neg_hi:[1,0,0]
  v_pk_fma_f32 v[110:111], v[4:5], v[18:19], v[110:111] op_sel:[1,0,0] op_sel_hi:[1,1,1] neg_lo:[1,0,0] neg_hi:[1,0,0]
  v_pk_fma_f32 v[124:125], v[4:5], v[20:21], v[124:125] op_sel:[1,0,0] op_sel_hi:[1,1,1] neg_lo:[1,0,0] neg_hi:[1,0,0]
  v_pk_fma_f32 v[126:127], v[4:5], v[22:23], v[126:127] op_sel:[1,0,0] op_sel_hi:[1,1,1] neg_lo:[1,0,0] neg_hi:[1,0,0]
  v_pk_mul_f32 v[108:109], v[108:109], v[124:125]
HOP61:
  s_cbranch_execz HOP77
  v_pk_mul_f32 v[110:111], v[110:111], v[126:127]
  v_pk_mul_f32 v[108:109], v[8:9], v[108:109] op_sel:[1,0] op_sel_hi:[1,1]
  v_pk_mul_f32 v[110:111], v[8:9], v[110:111] op_sel:[1,0] op_sel_hi:[1,1]
  v_cvt_pk_bf16_f32 v56, v108, v109
  v_cvt_pk_bf16_f32 v57, v110, v111
  v_pk_fma_f32 v[140:141], v[4:5], v[24:25], v[140:141] op_sel:[1,0,0] op_sel_hi:[1,1,1] neg_lo:[1,0,0] neg_hi:[1,0,0]
  v_pk_fma_f32 v[142:143], v[4:5], v[26:27], v[142:143] op_sel:[1,0,0] op_sel_hi:[1,1,1] neg_lo:[1,0,0] neg_hi:[1,0,0]
  v_pk_fma_f32 v[156:157], v[4:5], v[28:29], v[156:157] op_sel:[1,0,0] op_sel_hi:[1,1,1] neg_lo:[1,0,0] neg_hi:[1,0,0]
  v_pk_fma_f32 v[158:159], v[4:5], v[30:31], v[158:159] op_sel:[1,0,0] op_sel_hi:[1,1,1] neg_lo:[1,0,0] neg_hi:[1,0,0]
  v_pk_mul_f32 v[140:141], v[140:141], v[156:157]
  v_pk_mul_f32 v[142:143], v[142:143], v[158:159]
  v_pk_mul_f32 v[140:141], v[8:9], v[140:141] op_sel:[1,0] op_sel_hi:[1,1]
  v_pk_mul_f32 v[142:143], v[8:9], v[142:143] op_sel:[1,0] op_sel_hi:[1,1]
  v_cvt_pk_bf16_f32 v58, v140, v141
  v_cvt_pk_bf16_f32 v59, v142, v143
  s_add_u32 s56, s72, 221184
  buffer_store_dwordx4 v[56:59], v11, s[40:43], s56 offen sc1
  v_pk_fma_f32 v[172:173], v[4:5], v[32:33], v[172:173] op_sel:[1,0,0] op_sel_hi:[1,1,1] neg_lo:[1,0,0] neg_hi:[1,0,0]
  v_pk_fma_f32 v[174:175], v[4:5], v[34:35], v[174:175] op_sel:[1,0,0] op_sel_hi:[1,1,1] neg_lo:[1,0,0] neg_hi:[1,0,0]
  v_pk_fma_f32 v[188:189], v[4:5], v[36:37], v[188:189] op_sel:[1,0,0] op_sel_hi:[1,1,1] neg_lo:[1,0,0] neg_hi:[1,0,0]
  v_pk_fma_f32 v[190:191], v[4:5], v[38:39], v[190:191] op_sel:[1,0,0] op_sel_hi:[1,1,1] neg_lo:[1,0,0] neg_hi:[1,0,0]
  v_pk_mul_f32 v[172:173], v[172:173], v[188:189]
  v_pk_mul_f32 v[174:175], v[174:175], v[190:191]
  v_pk_mul_f32 v[172:173], v[8:9], v[172:173] op_sel:[1,0] op_sel_hi:[1,1]
  v_pk_mul_f32 v[174:175], v[8:9], v[174:175] op_sel:[1,0] op_sel_hi:[1,1]
  v_cvt_pk_bf16_f32 v60, v172, v173
  v_cvt_pk_bf16_f32 v61, v174, v175
  v_pk_fma_f32 v[204:205], v[4:5], v[40:41], v[204:205] op_sel:[1,0,0] op_sel_hi:[1,1,1] neg_lo:[1,0,0] neg_hi:[1,0,0]
  v_pk_fma_f32 v[206:207], v[4:5], v[42:43], v[206:207] op_sel:[1,0,0] op_sel_hi:[1,1,1] neg_lo:[1,0,0] neg_hi:[1,0,0]
  v_pk_fma_f32 v[220:221], v[4:5], v[44:45], v[220:221] op_sel:[1,0,0] op_sel_hi:[1,1,1] neg_lo:[1,0,0] neg_hi:[1,0,0]
HOP62:
  s_cbranch_execz HOP78
  v_pk_fma_f32 v[222:223], v[4:5], v[46:47], v[222:223] op_sel:[1,0,0] op_sel_hi:[1,1,1] neg_lo:[1,0,0] neg_hi:[1,0,0]
  v_pk_mul_f32 v[204:205], v[204:205], v[220:221]
  v_pk_mul_f32 v[206:207], v[206:207], v[222:223]
  v_pk_mul_f32 v[204:205], v[8:9], v[204:205] op_sel:[1,0] op_sel_hi:[1,1]
  v_pk_mul_f32 v[206:207], v[8:9], v[206:207] op_sel:[1,0] op_sel_hi:[1,1]
  v_cvt_pk_bf16_f32 v62, v204, v205
  v_cvt_pk_bf16_f32 v63, v206, v207
  s_add_u32 s56, s72, 222208
  buffer_store_dwordx4 v[60:63], v11, s[40:43], s56 offen sc1
  v_pk_fma_f32 v[236:237], v[4:5], v[48:49], v[236:237] op_sel:[1,0,0] op_sel_hi:[1,1,1] neg_lo:[1,0,0] neg_hi:[1,0,0]
  v_pk_fma_f32 v[238:239], v[4:5], v[50:51], v[238:239] op_sel:[1,0,0] op_sel_hi:[1,1,1] neg_lo:[1,0,0] neg_hi:[1,0,0]
  v_pk_fma_f32 v[252:253], v[4:5], v[52:53], v[252:253] op_sel:[1,0,0] op_sel_hi:[1,1,1] neg_lo:[1,0,0] neg_hi:[1,0,0]
  v_pk_fma_f32 v[254:255], v[4:5], v[54:55], v[254:255] op_sel:[1,0,0] op_sel_hi:[1,1,1] neg_lo:[1,0,0] neg_hi:[1,0,0]
  v_pk_mul_f32 v[236:237], v[236:237], v[252:253]
  v_pk_mul_f32 v[238:239], v[238:239], v[254:255]
  v_pk_mul_f32 v[236:237], v[8:9], v[236:237] op_sel:[1,0] op_sel_hi:[1,1]
  v_pk_mul_f32 v[238:239], v[8:9], v[238:239] op_sel:[1,0] op_sel_hi:[1,1]
  v_cvt_pk_bf16_f32 v66, v236, v237
  v_cvt_pk_bf16_f32 v67, v238, v239
  s_add_u32 s56, s72, 223232
  buffer_store_dwordx2 v[66:67], v12, s[40:43], s56 offen sc1
  s_branch L_cmp_pub
L_qh1:
  v_pk_mul_f32 v[6:7], v[6:7], v[6:7]
  v_pk_mul_f32 v[8:9], v[8:9], v[8:9]
  v_pk_fma_f32 v[128:129], v[2:3], v[24:25], v[128:129] op_sel:[0,0,0] op_sel_hi:[0,1,1] neg_lo:[1,0,0] neg_hi:[1,0,0]
  v_pk_fma_f32 v[130:131], v[2:3], v[26:27], v[130:131] op_sel:[0,0,0] op_sel_hi:[0,1,1] neg_lo:[1,0,0] neg_hi:[1,0,0]
  v_pk_fma_f32 v[144:145], v[2:3], v[28:29], v[144:145] op_sel:[0,0,0] op_sel_hi:[0,1,1] neg_lo:[1,0,0] neg_hi:[1,0,0]
  v_pk_fma_f32 v[146:147], v[2:3], v[30:31], v[146:147] op_sel:[0,0,0] op_sel_hi:[0,1,1] neg_lo:[1,0,0] neg_hi:[1,0,0]
  v_pk_mul_f32 v[128:129], v[128:129], v[144:145]
  v_pk_mul_f32 v[130:131], v[130:131], v[146:147]
  v_pk_mul_f32 v[128:129], v[6:7], v[128:129] op_sel:[0,0] op_sel_hi:[0,1]
HOP63:
  s_cbranch_execz HOP79
  v_pk_mul_f32 v[130:131], v[6:7], v[130:131] op_sel:[0,0] op_sel_hi:[0,1]
  v_cvt_pk_bf16_f32 v56, v128, v129
  v_cvt_pk_bf16_f32 v57, v130, v131
  v_pk_fma_f32 v[160:161], v[2:3], v[32:33], v[160:161] op_sel:[0,0,0] op_sel_hi:[0,1,1] neg_lo:[1,0,0] neg_hi:[1,0,0]
  v_pk_fma_f32 v[162:163], v[2:3], v[34:35], v[162:163] op_sel:[0,0,0] op_sel_hi:[0,1,1] neg_lo:[1,0,0] neg_hi:[1,0,0]
  v_pk_fma_f32 v[176:177], v[2:3], v[36:37], v[176:177] op_sel:[0,0,0] op_sel_hi:[0,1,1] neg_lo:[1,0,0] neg_hi:[1,0,0]
  v_pk_fma_f32 v[178:179], v[2:3], v[38:39], v[178:179] op_sel:[0,0,0] op_sel_hi:[0,1,1] neg_lo:[1,0,0] neg_hi:[1,0,0]
  v_pk_mul_f32 v[160:161], v[160:161], v[176:177]
  v_pk_mul_f32 v[162:163], v[162:163], v[178:179]
  v_pk_mul_f32 v[160:161], v[6:7], v[160:161] op_sel:[0,0] op_sel_hi:[0,1]
  v_pk_mul_f32 v[162:163], v[6:7], v[162:163] op_sel:[0,0] op_sel_hi:[0,1]
  v_cvt_pk_bf16_f32 v58, v160, v161
  v_cvt_pk_bf16_f32 v59, v162, v163
  s_add_u32 s56, s72, 3072
  buffer_store_dwordx4 v[56:59], v11, s[40:43], s56 offen sc1
  v_pk_fma_f32 v[192:193], v[2:3], v[40:41], v[192:193] op_sel:[0,0,0] op_sel_hi:[0,1,1] neg_lo:[1,0,0] neg_hi:[1,0,0]
  v_pk_fma_f32 v[194:195], v[2:3], v[42:43], v[194:195] op_sel:[0,0,0] op_sel_hi:[0,1,1] neg_lo:[1,0,0] neg_hi:[1,0,0]
  v_pk_fma_f32 v[208:209], v[2:3], v[44:45], v[208:209] op_sel:[0,0,0] op_sel_hi:[0,1,1] neg_lo:[1,0,0] neg_hi:[1,0,0]
  v_pk_fma_f32 v[210:211], v[2:3], v[46:47], v[210:211] op_sel:[0,0,0] op_sel_hi:[0,1,1] neg_lo:[1,0,0] neg_hi:[1,0,0]
  v_pk_mul_f32 v[192:193], v[192:193], v[208:209]
  v_pk_mul_f32 v[194:195], v[194:195], v[210:211]
  v_pk_mul_f32 v[192:193], v[6:7], v[192:193] op_sel:[0,0] op_sel_hi:[0,1]
  v_pk_mul_f32 v[194:195], v[6:7], v[194:195] op_sel:[0,0] op_sel_hi:[0,1]
  v_cvt_pk_bf16_f32 v60, v192, v193
  v_cvt_pk_bf16_f32 v61, v194, v195
  v_pk_fma_f32 v[224:225], v[2:3], v[48:49], v[224:225] op_sel:[0,0,0] op_sel_hi:[0,1,1] neg_lo:[1,0,0] neg_hi:[1,0,0]
  v_pk_fma_f32 v[226:227], v[2:3], v[50:51], v[226:227] op_sel:[0,0,0] op_sel_hi:[0,1,1] neg_lo:[1,0,0] neg_hi:[1,0,0]
  v_pk_fma_f32 v[240:241], v[2:3], v[52:53], v[240:241] op_sel:[0,0,0] op_sel_hi:[0,1,1] neg_lo:[1,0,0] neg_hi:[1,0,0]
  v_pk_fma_f32 v[242:243], v[2:3], v[54:55], v[242:243] op_sel:[0,0,0] op_sel_hi:[0,1,1] neg_lo:[1,0,0] neg_hi:[1,0,0]
  v_pk_mul_f32 v[224:225], v[224:225], v[240:241]
HOP64:
  s_cbranch_execz HOP80
  v_pk_mul_f32 v[226:227], v[226:227], v[242:243]
  v_pk_mul_f32 v[224:225], v[6:7], v[224:225] op_sel:[0,0] op_sel_hi:[0,1]
  v_pk_mul_f32 v[226:227], v[6:7], v[226:227] op_sel:[0,0] op_sel_hi:[0,1]
  v_cvt_pk_bf16_f32 v62, v224, v225
  v_cvt_pk_bf16_f32 v63, v226, v227
  s_add_u32 s56, s72, 4096
  buffer_store_dwordx4 v[60:63], v11, s[40:43], s56 offen sc1
  v_pk_fma_f32 v[96:97], v[2:3], v[16:17], v[96:97] op_sel:[0,0,0] op_sel_hi:[0,1,1] neg_lo:[1,0,0] neg_hi:[1,0,0]
  v_pk_fma_f32 v[98:99], v[2:3], v[18:19], v[98:99] op_sel:[0,0,0] op_sel_hi:[0,1,1] neg_lo:[1,0,0] neg_hi:[1,0,0]
  v_pk_fma_f32 v[112:113], v[2:3], v[20:21], v[112:113] op_sel:[0,0,0] op_sel_hi:[0,1,1] neg_lo:[1,0,0] neg_hi:[1,0,0]
  v_pk_fma_f32 v[114:115], v[2:3], v[22:23], v[114:115] op_sel:[0,0,0] op_sel_hi:[0,1,1] neg_lo:[1,0,0] neg_hi:[1,0,0]
  v_pk_mul_f32 v[96:97], v[96:97], v[112:113]
  v_pk_mul_f32 v[98:99], v[98:99], v[114:115]
  v_pk_mul_f32 v[96:97], v[6:7], v[96:97] op_sel:[0,0] op_sel_hi:[0,1]
  v_pk_mul_f32 v[98:99], v[6:7], v[98:99] op_sel:[0,0] op_sel_hi:[0,1]
  v_cvt_pk_bf16_f32 v64, v96, v97
  v_cvt_pk_bf16_f32 v65, v98, v99
  s_add_u32 s56, s72, 2048
  buffer_store_dwordx2 v[64:65], v12, s[40:43], s56 offen sc1
  v_pk_fma_f32 v[132:133], v[2:3], v[24:25], v[132:133] op_sel:[1,0,0] op_sel_hi:[1,1,1] neg_lo:[1,0,0] neg_hi:[1,0,0]
  v_pk_fma_f32 v[134:135], v[2:3], v[26:27], v[134:135] op_sel:[1,0,0] op_sel_hi:[1,1,1] neg_lo:[1,0,0] neg_hi:[1,0,0]
  v_pk_fma_f32 v[148:149], v[2:3], v[28:29], v[148:149] op_sel:[1,0,0] op_sel_hi:[1,1,1] neg_lo:[1,0,0] neg_hi:[1,0,0]
  v_pk_fma_f32 v[150:151], v[2:3], v[30:31], v[150:151] op_sel:[1,0,0] op_sel_hi:[1,1,1] neg_lo:[1,0,0] neg_hi:[1,0,0]
  v_pk_mul_f32 v[132:133], v[132:133], v[148:149]
  v_pk_mul_f32 v[134:135], v[134:135], v[150:151]
  v_pk_mul_f32 v[132:133], v[6:7], v[132:133] op_sel:[1,0] op_sel_hi:[1,1]
  v_pk_mul_f32 v[134:135], v[6:7], v[134:135] op_sel:[1,0] op_sel_hi:[1,1]
  v_cvt_pk_bf16_f32 v56, v132, v133
  v_cvt_pk_bf16_f32 v57, v134, v135
  v_pk_fma_f32 v[164:165], v[2:3], v[32:33], v[164:165] op_sel:[1,0,0] op_sel_hi:[1,1,1] neg_lo:[1,0,0] neg_hi:[1,0,0]
HOP65:
  s_cbranch_execz HOP81
  v_pk_fma_f32 v[166:167], v[2:3], v[34:35], v[166:167] op_sel:[1,0,0] op_sel_hi:[1,1,1] neg_lo:[1,0,0] neg_hi:[1,0,0]
  v_pk_fma_f32 v[180:181], v[2:3], v[36:37], v[180:181] op_sel:[1,0,0] op_sel_hi:[1,1,1] neg_lo:[1,0,0] neg_hi:[1,0,0]
  v_pk_fma_f32 v[182:183], v[2:3], v[38:39], v[182:183] op_sel:[1,0,0] op_sel_hi:[1,1,1] neg_lo:[1,0,0] neg_hi:[1,0,0]
  v_pk_mul_f32 v[164:165], v[164:165], v[180:181]
  v_pk_mul_f32 v[166:167], v[166:167], v[182:183]
  v_pk_mul_f32 v[164:165], v[6:7], v[164:165] op_sel:[1,0] op_sel_hi:[1,1]
  v_pk_mul_f32 v[166:167], v[6:7], v[166:167] op_sel:[1,0] op_sel_hi:[1,1]
  v_cvt_pk_bf16_f32 v58, v164, v165
  v_cvt_pk_bf16_f32 v59, v166, v167
  s_add_u32 s56, s72, 76800
  buffer_store_dwordx4 v[56:59], v11, s[40:43], s56 offen sc1
  v_pk_fma_f32 v[196:197], v[2:3], v[40:41], v[196:197] op_sel:[1,0,0] op_sel_hi:[1,1,1] neg_lo:[1,0,0] neg_hi:[1,0,0]
  v_pk_fma_f32 v[198:199], v[2:3], v[42:43], v[198:199] op_sel:[1,0,0] op_sel_hi:[1,1,1] neg_lo:[1,0,0] neg_hi:[1,0,0]
  v_pk_fma_f32 v[212:213], v[2:3], v[44:45], v[212:213] op_sel:[1,0,0] op_sel_hi:[1,1,1] neg_lo:[1,0,0] neg_hi:[1,0,0]
  v_pk_fma_f32 v[214:215], v[2:3], v[46:47], v[214:215] op_sel:[1,0,0] op_sel_hi:[1,1,1] neg_lo:[1,0,0] neg_hi:[1,0,0]
  v_pk_mul_f32 v[196:197], v[196:197], v[212:213]
  v_pk_mul_f32 v[198:199], v[198:199], v[214:215]
  v_pk_mul_f32 v[196:197], v[6:7], v[196:197] op_sel:[1,0] op_sel_hi:[1,1]
  v_pk_mul_f32 v[198:199], v[6:7], v[198:199] op_sel:[1,0] op_sel_hi:[1,1]
  v_cvt_pk_bf16_f32 v60, v196, v197
  v_cvt_pk_bf16_f32 v61, v198, v199
  v_pk_fma_f32 v[228:229], v[2:3], v[48:49], v[228:229] op_sel:[1,0,0] op_sel_hi:[1,1,1] neg_lo:[1,0,0] neg_hi:[1,0,0]
  v_pk_fma_f32 v[230:231], v[2:3], v[50:51], v[230:231] op_sel:[1,0,0] op_sel_hi:[1,1,1] neg_lo:[1,0,0] neg_hi:[1,0,0]
  v_pk_fma_f32 v[244:245], v[2:3], v[52:53], v[244:245] op_sel:[1,0,0] op_sel_hi:[1,1,1] neg_lo:[1,0,0] neg_hi:[1,0,0]
  v_pk_fma_f32 v[246:247], v[2:3], v[54:55], v[246:247] op_sel:[1,0,0] op_sel_hi:[1,1,1] neg_lo:[1,0,0] neg_hi:[1,0,0]
  v_pk_mul_f32 v[228:229], v[228:229], v[244:245]
  v_pk_mul_f32 v[230:231], v[230:231], v[246:247]
  v_pk_mul_f32 v[228:229], v[6:7], v[228:229] op_sel:[1,0] op_sel_hi:[1,1]
  v_pk_mul_f32 v[230:231], v[6:7], v[230:231] op_sel:[1,0] op_sel_hi:[1,1]
  v_cvt_pk_bf16_f32 v62, v228, v229
HOP66:
  s_cbranch_execz HOP82
  v_cvt_pk_bf16_f32 v63, v230, v231
  s_add_u32 s56, s72, 77824
  buffer_store_dwordx4 v[60:63], v11, s[40:43], s56 offen sc1
  v_pk_fma_f32 v[100:101], v[2:3], v[16:17], v[100:101] op_sel:[1,0,0] op_sel_hi:[1,1,1] neg_lo:[1,0,0] neg_hi:[1,0,0]
  v_pk_fma_f32 v[102:103], v[2:3], v[18:19], v[102:103] op_sel:[1,0,0] op_sel_hi:[1,1,1] neg_lo:[1,0,0] neg_hi:[1,0,0]
  v_pk_fma_f32 v[116:117], v[2:3], v[20:21], v[116:117] op_sel:[1,0,0] op_sel_hi:[1,1,1] neg_lo:[1,0,0] neg_hi:[1,0,0]
  v_pk_fma_f32 v[118:119], v[2:3], v[22:23], v[118:119] op_sel:[1,0,0] op_sel_hi:[1,1,1] neg_lo:[1,0,0] neg_hi:[1,0,0]
  v_pk_mul_f32 v[100:101], v[100:101], v[116:117]
  v_pk_mul_f32 v[102:103], v[102:103], v[118:119]
  v_pk_mul_f32 v[100:101], v[6:7], v[100:101] op_sel:[1,0] op_sel_hi:[1,1]
  v_pk_mul_f32 v[102:103], v[6:7], v[102:103] op_sel:[1,0] op_sel_hi:[1,1]
  v_cvt_pk_bf16_f32 v66, v100, v101
  v_cvt_pk_bf16_f32 v67, v102, v103
  s_add_u32 s56, s72, 75776
  buffer_store_dwordx2 v[66:67], v12, s[40:43], s56 offen sc1
  v_pk_fma_f32 v[136:137], v[4:5], v[24:25], v[136:137] op_sel:[0,0,0] op_sel_hi:[0,1,1] neg_lo:[1,0,0] neg_hi:[1,0,0]
  v_pk_fma_f32 v[138:139], v[4:5], v[26:27], v[138:139] op_sel:[0,0,0] op_sel_hi:[0,1,1] neg_lo:[1,0,0] neg_hi:[1,0,0]
  v_pk_fma_f32 v[152:153], v[4:5], v[28:29], v[152:153] op_sel:[0,0,0] op_sel_hi:[0,1,1] neg_lo:[1,0,0] neg_hi:[1,0,0]
  v_pk_fma_f32 v[154:155], v[4:5], v[30:31], v[154:155] op_sel:[0,0,0] op_sel_hi:[0,1,1] neg_lo:[1,0,0] neg_hi:[1,0,0]
  v_pk_mul_f32 v[136:137], v[136:137], v[152:153]
  v_pk_mul_f32 v[138:139], v[138:139], v[154:155]
  v_pk_mul_f32 v[136:137], v[8:9], v[136:137] op_sel:[0,0] op_sel_hi:[0,1]
  v_pk_mul_f32 v[138:139], v[8:9], v[138:139] op_sel:[0,0] op_sel_hi:[0,1]
  v_cvt_pk_bf16_f32 v56, v136, v137
  v_cvt_pk_bf16_f32 v57, v138, v139
  v_pk_fma_f32 v[168:169], v[4:5], v[32:33], v[168:169] op_sel:[0,0,0] op_sel_hi:[0,1,1] neg_lo:[1,0,0] neg_hi:[1,0,0]
  v_pk_fma_f32 v[170:171], v[4:5], v[34:35], v[170:171] op_sel:[0,0,0] op_sel_hi:[0,1,1] neg_lo:[1,0,0] neg_hi:[1,0,0]
  v_pk_fma_f32 v[184:185], v[4:5], v[36:37], v[184:185] op_sel:[0,0,0] op_sel_hi:[0,1,1] neg_lo:[1,0,0] neg_hi:[1,0,0]
  v_pk_fma_f32 v[186:187], v[4:5], v[38:39], v[186:187] op_sel:[0,0,0] op_sel_hi:[0,1,1] neg_lo:[1,0,0] neg_hi:[1,0,0]
  v_pk_mul_f32 v[168:169], v[168:169], v[184:185]
HOP67:
  s_cbranch_execz HOP83
  v_pk_mul_f32 v[170:171], v[170:171], v[186:187]
  v_pk_mul_f32 v[168:169], v[8:9], v[168:169] op_sel:[0,0] op_sel_hi:[0,1]
  v_pk_mul_f32 v[170:171], v[8:9], v[170:171] op_sel:[0,0] op_sel_hi:[0,1]
  v_cvt_pk_bf16_f32 v58, v168, v169
  v_cvt_pk_bf16_f32 v59, v170, v171
  s_add_u32 s56, s72, 150528
  buffer_store_dwordx4 v[56:59], v11, s[40:43], s56 offen sc1
  v_pk_fma_f32 v[200:201], v[4:5], v[40:41], v[200:201] op_sel:[0,0,0] op_sel_hi:[0,1,1] neg_lo:[1,0,0] neg_hi:[1,0,0]
  v_pk_fma_f32 v[202:203], v[4:5], v[42:43], v[202:203] op_sel:[0,0,0] op_sel_hi:[0,1,1] neg_lo:[1,0,0] neg_hi:[1,0,0]
  v_pk_fma_f32 v[216:217], v[4:5], v[44:45], v[216:217] op_sel:[0,0,0] op_sel_hi:[0,1,1] neg_lo:[1,0,0] neg_hi:[1,0,0]
  v_pk_fma_f32 v[218:219], v[4:5], v[46:47], v[218:219] op_sel:[0,0,0] op_sel_hi:[0,1,1] neg_lo:[1,0,0] neg_hi:[1,0,0]
  v_pk_mul_f32 v[200:201], v[200:201], v[216:217]
  v_pk_mul_f32 v[202:203], v[202:203], v[218:219]
  v_pk_mul_f32 v[200:201], v[8:9], v[200:201] op_sel:[0,0] op_sel_hi:[0,1]
  v_pk_mul_f32 v[202:203], v[8:9], v[202:203] op_sel:[0,0] op_sel_hi:[0,1]
  v_cvt_pk_bf16_f32 v60, v200, v201
  v_cvt_pk_bf16_f32 v61, v202, v203
  v_pk_fma_f32 v[232:233], v[4:5], v[48:49], v[232:233] op_sel:[0,0,0] op_sel_hi:[0,1,1] neg_lo:[1,0,0] neg_hi:[1,0,0]
  v_pk_fma_f32 v[234:235], v[4:5], v[50:51], v[234:235] op_sel:[0,0,0] op_sel_hi:[0,1,1] neg_lo:[1,0,0] neg_hi:[1,0,0]
  v_pk_fma_f32 v[248:249], v[4:5], v[52:53], v[248:249] op_sel:[0,0,0] op_sel_hi:[0,1,1] neg_lo:[1,0,0] neg_hi:[1,0,0]
  v_pk_fma_f32 v[250:251], v[4:5], v[54:55], v[250:251] op_sel:[0,0,0] op_sel_hi:[0,1,1] neg_lo:[1,0,0] neg_hi:[1,0,0]
  v_pk_mul_f32 v[232:233], v[232:233], v[248:249]
  v_pk_mul_f32 v[234:235], v[234:235], v[250:251]
  v_pk_mul_f32 v[232:233], v[8:9], v[232:233] op_sel:[0,0] op_sel_hi:[0,1]
  v_pk_mul_f32 v[234:235], v[8:9], v[234:235] op_sel:[0,0] op_sel_hi:[0,1]
  v_cvt_pk_bf16_f32 v62, v232, v233
  v_cvt_pk_bf16_f32 v63, v234, v235
  s_add_u32 s56, s72, 151552
  buffer_store_dwordx4 v[60:63], v11, s[40:43], s56 offen sc1
  v_pk_fma_f32 v[104:105], v[4:5], v[16:17], v[104:105] op_sel:[0,0,0] op_sel_hi:[0,1,1] neg_lo:[1,0,0] neg_hi:[1,0,0]
HOP68:
  s_cbranch_execz HOP84
  v_pk_fma_f32 v[106:107], v[4:5], v[18:19], v[106:107] op_sel:[0,0,0] op_sel_hi:[0,1,1] neg_lo:[1,0,0] neg_hi:[1,0,0]
  v_pk_fma_f32 v[120:121], v[4:5], v[20:21], v[120:121] op_sel:[0,0,0] op_sel_hi:[0,1,1] neg_lo:[1,0,0] neg_hi:[1,0,0]
  v_pk_fma_f32 v[122:123], v[4:5], v[22:23], v[122:123] op_sel:[0,0,0] op_sel_hi:[0,1,1] neg_lo:[1,0,0] neg_hi:[1,0,0]
  v_pk_mul_f32 v[104:105], v[104:105], v[120:121]
  v_pk_mul_f32 v[106:107], v[106:107], v[122:123]
  v_pk_mul_f32 v[104:105], v[8:9], v[104:105] op_sel:[0,0] op_sel_hi:[0,1]
  v_pk_mul_f32 v[106:107], v[8:9], v[106:107] op_sel:[0,0] op_sel_hi:[0,1]
  v_cvt_pk_bf16_f32 v64, v104, v105
  v_cvt_pk_bf16_f32 v65, v106, v107
  s_add_u32 s56, s72, 149504
  buffer_store_dwordx2 v[64:65], v12, s[40:43], s56 offen sc1
  v_pk_fma_f32 v[140:141], v[4:5], v[24:25], v[140:141] op_sel:[1,0,0] op_sel_hi:[1,1,1] neg_lo:[1,0,0] neg_hi:[1,0,0]
  v_pk_fma_f32 v[142:143], v[4:5], v[26:27], v[142:143] op_sel:[1,0,0] op_sel_hi:[1,1,1] neg_lo:[1,0,0] neg_hi:[1,0,0]
  v_pk_fma_f32 v[156:157], v[4:5], v[28:29], v[156:157] op_sel:[1,0,0] op_sel_hi:[1,1,1] neg_lo:[1,0,0] neg_hi:[1,0,0]
  v_pk_fma_f32 v[158:159], v[4:5], v[30:31], v[158:159] op_sel:[1,0,0] op_sel_hi:[1,1,1] neg_lo:[1,0,0] neg_hi:[1,0,0]
  v_pk_mul_f32 v[140:141], v[140:141], v[156:157]
  v_pk_mul_f32 v[142:143], v[142:143], v[158:159]
  v_pk_mul_f32 v[140:141], v[8:9], v[140:141] op_sel:[1,0] op_sel_hi:[1,1]
  v_pk_mul_f32 v[142:143], v[8:9], v[142:143] op_sel:[1,0] op_sel_hi:[1,1]
  v_cvt_pk_bf16_f32 v56, v140, v141
  v_cvt_pk_bf16_f32 v57, v142, v143
  v_pk_fma_f32 v[172:173], v[4:5], v[32:33], v[172:173] op_sel:[1,0,0] op_sel_hi:[1,1,1] neg_lo:[1,0,0] neg_hi:[1,0,0]
  v_pk_fma_f32 v[174:175], v[4:5], v[34:35], v[174:175] op_sel:[1,0,0] op_sel_hi:[1,1,1] neg_lo:[1,0,0] neg_hi:[1,0,0]
  v_pk_fma_f32 v[188:189], v[4:5], v[36:37], v[188:189] op_sel:[1,0,0] op_sel_hi:[1,1,1] neg_lo:[1,0,0] neg_hi:[1,0,0]
  v_pk_fma_f32 v[190:191], v[4:5], v[38:39], v[190:191] op_sel:[1,0,0] op_sel_hi:[1,1,1] neg_lo:[1,0,0] neg_hi:[1,0,0]
  v_pk_mul_f32 v[172:173], v[172:173], v[188:189]
  v_pk_mul_f32 v[174:175], v[174:175], v[190:191]
  v_pk_mul_f32 v[172:173], v[8:9], v[172:173] op_sel:[1,0] op_sel_hi:[1,1]
  v_pk_mul_f32 v[174:175], v[8:9], v[174:175] op_sel:[1,0] op_sel_hi:[1,1]
  v_cvt_pk_bf16_f32 v58, v172, v173
HOP69:
  s_cbranch_execz HOP85
  v_cvt_pk_bf16_f32 v59, v174, v175
  s_add_u32 s56, s72, 224256
  buffer_store_dwordx4 v[56:59], v11, s[40:43], s56 offen sc1
  v_pk_fma_f32 v[204:205], v[4:5], v[40:41], v[204:205] op_sel:[1,0,0] op_sel_hi:[1,1,1] neg_lo:[1,0,0] neg_hi:[1,0,0]
  v_pk_fma_f32 v[206:207], v[4:5], v[42:43], v[206:207] op_sel:[1,0,0] op_sel_hi:[1,1,1] neg_lo:[1,0,0] neg_hi:[1,0,0]
  v_pk_fma_f32 v[220:221], v[4:5], v[44:45], v[220:221] op_sel:[1,0,0] op_sel_hi:[1,1,1] neg_lo:[1,0,0] neg_hi:[1,0,0]
  v_pk_fma_f32 v[222:223], v[4:5], v[46:47], v[222:223] op_sel:[1,0,0] op_sel_hi:[1,1,1] neg_lo:[1,0,0] neg_hi:[1,0,0]
  v_pk_mul_f32 v[204:205], v[204:205], v[220:221]
  v_pk_mul_f32 v[206:207], v[206:207], v[222:223]
  v_pk_mul_f32 v[204:205], v[8:9], v[204:205] op_sel:[1,0] op_sel_hi:[1,1]
  v_pk_mul_f32 v[206:207], v[8:9], v[206:207] op_sel:[1,0] op_sel_hi:[1,1]
  v_cvt_pk_bf16_f32 v60, v204, v205
  v_cvt_pk_bf16_f32 v61, v206, v207
  v_pk_fma_f32 v[236:237], v[4:5], v[48:49], v[236:237] op_sel:[1,0,0] op_sel_hi:[1,1,1] neg_lo:[1,0,0] neg_hi:[1,0,0]
  v_pk_fma_f32 v[238:239], v[4:5], v[50:51], v[238:239] op_sel:[1,0,0] op_sel_hi:[1,1,1] neg_lo:[1,0,0] neg_hi:[1,0,0]
  v_pk_fma_f32 v[252:253], v[4:5], v[52:53], v[252:253] op_sel:[1,0,0] op_sel_hi:[1,1,1] neg_lo:[1,0,0] neg_hi:[1,0,0]
  v_pk_fma_f32 v[254:255], v[4:5], v[54:55], v[254:255] op_sel:[1,0,0] op_sel_hi:[1,1,1] neg_lo:[1,0,0] neg_hi:[1,0,0]
  v_pk_mul_f32 v[236:237], v[236:237], v[252:253]
  v_pk_mul_f32 v[238:239], v[238:239], v[254:255]
  v_pk_mul_f32 v[236:237], v[8:9], v[236:237] op_sel:[1,0] op_sel_hi:[1,1]
  v_pk_mul_f32 v[238:239], v[8:9], v[238:239] op_sel:[1,0] op_sel_hi:[1,1]
  v_cvt_pk_bf16_f32 v62, v236, v237
  v_cvt_pk_bf16_f32 v63, v238, v239
  s_add_u32 s56, s72, 225280
  buffer_store_dwordx4 v[60:63], v11, s[40:43], s56 offen sc1
  v_pk_fma_f32 v[108:109], v[4:5], v[16:17], v[108:109] op_sel:[1,0,0] op_sel_hi:[1,1,1] neg_lo:[1,0,0] neg_hi:[1,0,0]
  v_pk_fma_f32 v[110:111], v[4:5], v[18:19], v[110:111] op_sel:[1,0,0] op_sel_hi:[1,1,1] neg_lo:[1,0,0] neg_hi:[1,0,0]
  v_pk_fma_f32 v[124:125], v[4:5], v[20:21], v[124:125] op_sel:[1,0,0] op_sel_hi:[1,1,1] neg_lo:[1,0,0] neg_hi:[1,0,0]
  v_pk_fma_f32 v[126:127], v[4:5], v[22:23], v[126:127] op_sel:[1,0,0] op_sel_hi:[1,1,1] neg_lo:[1,0,0] neg_hi:[1,0,0]
  v_pk_mul_f32 v[108:109], v[108:109], v[124:125]
HOP70:
  s_cbranch_execz HOP86
  v_pk_mul_f32 v[110:111], v[110:111], v[126:127]
  v_pk_mul_f32 v[108:109], v[8:9], v[108:109] op_sel:[1,0] op_sel_hi:[1,1]
  v_pk_mul_f32 v[110:111], v[8:9], v[110:111] op_sel:[1,0] op_sel_hi:[1,1]
  v_cvt_pk_bf16_f32 v66, v108, v109
  v_cvt_pk_bf16_f32 v67, v110, v111
  s_add_u32 s56, s72, 223232
  buffer_store_dwordx2 v[66:67], v12, s[40:43], s56 offen sc1
L_cmp_pub:
HOP71:
  s_cbranch_execz HOP87
  v_lshlrev_b32 v15, 4, v0
  s_cmp_lt_u32 s66, 28
  s_cbranch_scc1 L_pre
  s_waitcnt vmcnt(0)
  s_branch L_pre2
L_pre:
  s_mul_i32 s53, s65, 72
  s_mul_i32 s54, s61, 5
  s_add_u32 s54, s54, 32
  s_add_u32 s54, s54, s53
  s_lshl_b32 s54, s54, 12
  s_add_u32 s80, s54, 9437184
  s_lshl_b32 s54, s61, 1
  s_add_u32 s54, s54, s53
  s_lshl_b32 s54, s54, 12
  s_add_u32 s81, s54, 9437184
  s_bitcmp1_b32 s46, 0
  s_cbranch_scc1 L_preQ
  s_add_u32 s56, s81, 0
  buffer_load_dwordx4 v[112:115], v15, s[40:43], s56 offen offset:0 sc1
  buffer_load_dwordx4 v[116:119], v15, s[40:43], s56 offen offset:1024 sc1
  buffer_load_dwordx4 v[120:123], v15, s[40:43], s56 offen offset:2048 sc1
  buffer_load_dwordx4 v[124:127], v15, s[40:43], s56 offen offset:3072 sc1
  s_add_u32 s56, s81, 4096
  buffer_load_dwordx4 v[128:131], v15, s[40:43], s56 offen offset:0 sc1
  buffer_load_dwordx4 v[132:135], v15, s[40:43], s56 offen offset:1024 sc1
  buffer_load_dwordx4 v[136:139], v15, s[40:43], s56 offen offset:2048 sc1
  buffer_load_dwordx4 v[140:143], v15, s[40:43], s56 offen offset:3072 sc1
  s_waitcnt vmcnt(8)
  s_branch L_pre2
L_preQ:
  s_waitcnt vmcnt(0)
L_pre2:
  v_mov_b32 v2, 152964
  v_mov_b32 v3, 1
  v_cmp_eq_u32 vcc, 0, v0
  s_nop 0
  s_and_saveexec_b64 s[74:75], vcc
  ds_add_rtn_u32 v3, v2, v3
  s_waitcnt lgkmcnt(0)
  s_mov_b64 exec, s[74:75]
  v_readfirstlane_b32 s54, v3
  s_bitcmp1_b32 s46, 0
  s_cselect_b32 s55, 3, 7
  s_cmp_eq_u32 s54, s55
  s_cbranch_scc0 L_pubc
  s_lshl_b32 s53, s45, 4
  s_add_u32 s53, s53, s46
  s_lshl_b32 s53, s53, 7
HOP72:
  s_cbranch_execz HOP88
  s_add_u32 s53, s53, 11960320
  v_mov_b32 v1, s53
  v_mov_b32 v2, s67
  v_cmp_eq_u32 vcc, 0, v0
  s_nop 0
  s_and_saveexec_b64 s[74:75], vcc
  buffer_store_dword v2, v1, s[40:43], 0 offen sc1
  s_mov_b64 exec, s[74:75]
L_pubc:
  s_cmp_lt_u32 s66, 28
  s_cbranch_scc0 L_fin
  s_bitcmp1_b32 s46, 0
  s_cbranch_scc1 L_postQ
  s_add_u32 s56, s81, 65536
  buffer_load_dwordx4 v[144:147], v15, s[40:43], s56 offen offset:0 sc1
  buffer_load_dwordx4 v[148:151], v15, s[40:43], s56 offen offset:1024 sc1
  buffer_load_dwordx4 v[152:155], v15, s[40:43], s56 offen offset:2048 sc1
  buffer_load_dwordx4 v[156:159], v15, s[40:43], s56 offen offset:3072 sc1
  s_add_u32 s56, s81, 69632
  buffer_load_dwordx4 v[160:163], v15, s[40:43], s56 offen offset:0 sc1
  buffer_load_dwordx4 v[164:167], v15, s[40:43], s56 offen offset:1024 sc1
  buffer_load_dwordx4 v[168:171], v15, s[40:43], s56 offen offset:2048 sc1
  buffer_load_dwordx4 v[172:175], v15, s[40:43], s56 offen offset:3072 sc1
  s_branch L_k2
L_postQ:
  s_add_u32 s56, s80, 0
  buffer_load_dwordx4 v[176:179], v15, s[40:43], s56 offen offset:0 sc1
  buffer_load_dwordx4 v[180:183], v15, s[40:43], s56 offen offset:1024 sc1
  buffer_load_dwordx4 v[184:187], v15, s[40:43], s56 offen offset:2048 sc1
  buffer_load_dwordx4 v[188:191], v15, s[40:43], s56 offen offset:3072 sc1
  s_add_u32 s56, s80, 4096
  buffer_load_dwordx4 v[192:195], v15, s[40:43], s56 offen offset:0 sc1
  buffer_load_dwordx4 v[196:199], v15, s[40:43], s56 offen offset:1024 sc1
  buffer_load_dwordx4 v[200:203], v15, s[40:43], s56 offen offset:2048 sc1
  buffer_load_dwordx4 v[204:207], v15, s[40:43], s56 offen offset:3072 sc1
  s_add_u32 s56, s80, 8192
  buffer_load_dwordx4 v[208:211], v15, s[40:43], s56 offen offset:0 sc1
  buffer_load_dwordx4 v[212:215], v15, s[40:43], s56 offen offset:1024 sc1
HOP73:
  s_cbranch_execz HOP89
  buffer_load_dwordx4 v[216:219], v15, s[40:43], s56 offen offset:2048 sc1
  buffer_load_dwordx4 v[220:223], v15, s[40:43], s56 offen offset:3072 sc1
  s_add_u32 s56, s80, 12288
  buffer_load_dwordx4 v[224:227], v15, s[40:43], s56 offen offset:0 sc1
  buffer_load_dwordx4 v[228:231], v15, s[40:43], s56 offen offset:1024 sc1
  buffer_load_dwordx4 v[232:235], v15, s[40:43], s56 offen offset:2048 sc1
  buffer_load_dwordx4 v[236:239], v15, s[40:43], s56 offen offset:3072 sc1
  s_add_u32 s56, s80, 16384
  buffer_load_dwordx4 v[240:243], v15, s[40:43], s56 offen offset:0 sc1
  buffer_load_dwordx4 v[244:247], v15, s[40:43], s56 offen offset:1024 sc1
  buffer_load_dwordx4 v[248:251], v15, s[40:43], s56 offen offset:2048 sc1
  buffer_load_dwordx4 v[252:255], v15, s[40:43], s56 offen offset:3072 sc1
  s_add_u32 s56, s81, 0
  buffer_load_dwordx4 v[112:115], v15, s[40:43], s56 offen offset:0 sc1
  buffer_load_dwordx4 v[116:119], v15, s[40:43], s56 offen offset:1024 sc1
  buffer_load_dwordx4 v[120:123], v15, s[40:43], s56 offen offset:2048 sc1
  buffer_load_dwordx4 v[124:127], v15, s[40:43], s56 offen offset:3072 sc1
  s_add_u32 s56, s81, 4096
  buffer_load_dwordx4 v[128:131], v15, s[40:43], s56 offen offset:0 sc1
  buffer_load_dwordx4 v[132:135], v15, s[40:43], s56 offen offset:1024 sc1
  buffer_load_dwordx4 v[136:139], v15, s[40:43], s56 offen offset:2048 sc1
  buffer_load_dwordx4 v[140:143], v15, s[40:43], s56 offen offset:3072 sc1
  s_add_u32 s56, s81, 65536
  buffer_load_dwordx4 v[144:147], v15, s[40:43], s56 offen offset:0 sc1
  buffer_load_dwordx4 v[148:151], v15, s[40:43], s56 offen offset:1024 sc1
  buffer_load_dwordx4 v[152:155], v15, s[40:43], s56 offen offset:2048 sc1
  buffer_load_dwordx4 v[156:159], v15, s[40:43], s56 offen offset:3072 sc1
  s_add_u32 s56, s81, 69632
  buffer_load_dwordx4 v[160:163], v15, s[40:43], s56 offen offset:0 sc1
  buffer_load_dwordx4 v[164:167], v15, s[40:43], s56 offen offset:1024 sc1
  buffer_load_dwordx4 v[168:171], v15, s[40:43], s56 offen offset:2048 sc1
HOP74:
  s_cbranch_execz HOP90
  buffer_load_dwordx4 v[172:175], v15, s[40:43], s56 offen offset:3072 sc1
  s_branch L_k2
L_tail_help:
  s_barrier
  v_mov_b32 v1, 152960
  ds_read_b32 v1, v1
  s_waitcnt lgkmcnt(0)
  v_readfirstlane_b32 s67, v1
  v_lshlrev_b32 v15, 4, v0
  s_cmp_lt_u32 s66, 28
  s_cbranch_scc0 L_th
  s_mul_i32 s53, s65, 72
  s_mul_i32 s54, s61, 5
  s_add_u32 s54, s54, 32
  s_add_u32 s54, s54, s53
  s_lshl_b32 s54, s54, 12
  s_add_u32 s80, s54, 9437184
  s_lshl_b32 s54, s61, 1
  s_add_u32 s54, s54, s53
  s_lshl_b32 s54, s54, 12
  s_add_u32 s81, s54, 9437184
  s_cmp_lt_u32 s44, 6
  s_cbranch_scc1 L_th45
  s_add_u32 s56, s80, 0
  buffer_load_dwordx4 v[176:179], v15, s[40:43], s56 offen offset:0 sc1
  buffer_load_dwordx4 v[180:183], v15, s[40:43], s56 offen offset:1024 sc1
  buffer_load_dwordx4 v[184:187], v15, s[40:43], s56 offen offset:2048 sc1
  buffer_load_dwordx4 v[188:191], v15, s[40:43], s56 offen offset:3072 sc1
  s_add_u32 s56, s80, 4096
  buffer_load_dwordx4 v[192:195], v15, s[40:43], s56 offen offset:0 sc1
  buffer_load_dwordx4 v[196:199], v15, s[40:43], s56 offen offset:1024 sc1
  buffer_load_dwordx4 v[200:203], v15, s[40:43], s56 offen offset:2048 sc1
  buffer_load_dwordx4 v[204:207], v15, s[40:43], s56 offen offset:3072 sc1
  s_add_u32 s56, s80, 8192
  buffer_load_dwordx4 v[208:211], v15, s[40:43], s56 offen offset:0 sc1
  buffer_load_dwordx4 v[212:215], v15, s[40:43], s56 offen offset:1024 sc1
  buffer_load_dwordx4 v[216:219], v15, s[40:43], s56 offen offset:2048 sc1
  buffer_load_dwordx4 v[220:223], v15, s[40:43], s56 offen offset:3072 sc1
  s_add_u32 s56, s80, 12288
  buffer_load_dwordx4 v[224:227], v15, s[40:43], s56 offen offset:0 sc1
HOP75:
  s_cbranch_execz HOP91
  buffer_load_dwordx4 v[228:231], v15, s[40:43], s56 offen offset:1024 sc1
  buffer_load_dwordx4 v[232:235], v15, s[40:43], s56 offen offset:2048 sc1
  buffer_load_dwordx4 v[236:239], v15, s[40:43], s56 offen offset:3072 sc1
L_th45:
  s_add_u32 s56, s80, 16384
  buffer_load_dwordx4 v[240:243], v15, s[40:43], s56 offen offset:0 sc1
  buffer_load_dwordx4 v[244:247], v15, s[40:43], s56 offen offset:1024 sc1
  buffer_load_dwordx4 v[248:251], v15, s[40:43], s56 offen offset:2048 sc1
  buffer_load_dwordx4 v[252:255], v15, s[40:43], s56 offen offset:3072 sc1
  s_bitcmp1_b32 s46, 0
  s_cbranch_scc0 L_th
  s_add_u32 s56, s81, 0
  buffer_load_dwordx4 v[112:115], v15, s[40:43], s56 offen offset:0 sc1
  buffer_load_dwordx4 v[116:119], v15, s[40:43], s56 offen offset:1024 sc1
  buffer_load_dwordx4 v[120:123], v15, s[40:43], s56 offen offset:2048 sc1
  buffer_load_dwordx4 v[124:127], v15, s[40:43], s56 offen offset:3072 sc1
  s_add_u32 s56, s81, 4096
  buffer_load_dwordx4 v[128:131], v15, s[40:43], s56 offen offset:0 sc1
  buffer_load_dwordx4 v[132:135], v15, s[40:43], s56 offen offset:1024 sc1
  buffer_load_dwordx4 v[136:139], v15, s[40:43], s56 offen offset:2048 sc1
  buffer_load_dwordx4 v[140:143], v15, s[40:43], s56 offen offset:3072 sc1
  s_add_u32 s56, s81, 65536
  buffer_load_dwordx4 v[144:147], v15, s[40:43], s56 offen offset:0 sc1
  buffer_load_dwordx4 v[148:151], v15, s[40:43], s56 offen offset:1024 sc1
  buffer_load_dwordx4 v[152:155], v15, s[40:43], s56 offen offset:2048 sc1
  buffer_load_dwordx4 v[156:159], v15, s[40:43], s56 offen offset:3072 sc1
  s_add_u32 s56, s81, 69632
  buffer_load_dwordx4 v[160:163], v15, s[40:43], s56 offen offset:0 sc1
  buffer_load_dwordx4 v[164:167], v15, s[40:43], s56 offen offset:1024 sc1
  buffer_load_dwordx4 v[168:171], v15, s[40:43], s56 offen offset:2048 sc1
  buffer_load_dwordx4 v[172:175], v15, s[40:43], s56 offen offset:3072 sc1
L_th:
  s_bitcmp1_b32 s46, 0
  s_cbranch_scc1 L_thq
  s_barrier
HOP76:
  s_cbranch_execz HOP92
  s_sub_u32 s53, s44, 4
  s_lshr_b32 s76, s53, 1
  s_and_b32 s77, s53, 1
  s_lshl_b32 s77, s77, 2
  s_lshl_b32 s53, s76, 3
  s_add_u32 s53, s53, s77
  s_lshl_b32 s53, s53, 10
  s_mul_i32 s54, s76, 9
  s_add_u32 s54, s54, s77
  s_lshl_b32 s54, s54, 10
  v_lshlrev_b32 v1, 4, v0
  v_add_u32 v2, s53, v1
  v_add_u32 v3, s54, v1
  v_lshlrev_b32 v4, 3, v0
  v_add_u32 v4, s54, v4
  ds_read_b128 v[32:35], v3 offset:0
  ds_read_b128 v[16:19], v2 offset:36864
  ds_read_b128 v[36:39], v3 offset:1024
  ds_read_b128 v[20:23], v2 offset:37888
  ds_read_b128 v[40:43], v3 offset:2048
  ds_read_b128 v[24:27], v2 offset:38912
  ds_read_b128 v[44:47], v3 offset:3072
  ds_read_b128 v[28:31], v2 offset:39936
  ds_read_b128 v[48:51], v3 offset:4096
  v_and_b32 v5, 15, v0
  s_lshl_b32 s55, s77, 4
  s_add_u32 s55, s55, 16
  v_add_u32 v6, s55, v5
  v_lshlrev_b32 v6, 2, v6
  v_add_u32 v6, 151104, v6
  ds_read_b32 v12, v6 offset:0
  ds_read_b32 v13, v6 offset:64
  ds_read_b32 v14, v6 offset:128
  ds_read_b32 v15, v6 offset:192
  v_lshrrev_b32 v7, 4, v0
  v_lshlrev_b32 v7, 2, v7
  v_sub_u32 v7, v5, v7
  v_add_u32 v7, 14, v7
  v_mov_b32 v8, 0x5555
  v_mov_b32 v9, 0
  v_lshlrev_b64 v[8:9], v7, v[8:9]
  v_lshrrev_b64 v[8:9], 12, v[8:9]
  s_or_b32 s55, s45, s77
HOP77:
  s_cbranch_execz HOP93
  s_cmp_eq_u32 s55, 0
  s_cselect_b32 s55, 0xffff0000, -1
  v_and_b32 v9, s55, v8
  v_mov_b32 v10, 0xff800000
  s_mov_b32 s78, 0x3e8b97f6
  s_waitcnt lgkmcnt(10)
  v_mfma_f32_16x16x32_bf16 v[72:75], v[36:39], v[16:19], 0
  v_mfma_f32_16x16x32_bf16 v[76:79], v[32:35], v[16:19], 0
  s_waitcnt lgkmcnt(8)
  v_mfma_f32_16x16x32_bf16 v[80:83], v[40:43], v[20:23], 0
  v_mfma_f32_16x16x32_bf16 v[84:87], v[36:39], v[20:23], 0
  s_waitcnt lgkmcnt(6)
  v_mfma_f32_16x16x32_bf16 v[88:91], v[44:47], v[24:27], 0
  v_mfma_f32_16x16x32_bf16 v[92:95], v[40:43], v[24:27], 0
  s_waitcnt lgkmcnt(4)
  v_mfma_f32_16x16x32_bf16 v[96:99], v[48:51], v[28:31], 0
  v_mfma_f32_16x16x32_bf16 v[100:103], v[44:47], v[28:31], 0
  ds_read_b64 v[52:53], v4 offset:18432
  ds_read_b64 v[54:55], v4 offset:19456
  ds_read_b64 v[56:57], v4 offset:20480
  ds_read_b64 v[58:59], v4 offset:21504
  ds_read_b64 v[60:61], v4 offset:22528
  ds_read_b64 v[62:63], v4 offset:18944
  ds_read_b64 v[64:65], v4 offset:19968
  ds_read_b64 v[66:67], v4 offset:20992
  ds_read_b64 v[68:69], v4 offset:22016
  ds_read_b64 v[70:71], v4 offset:23040
  v_bfe_i32 v120, v9, 16, 1
  v_bfe_i32 v124, v9, 0, 1
  v_bfe_i32 v121, v9, 17, 1
  v_bfe_i32 v125, v9, 1, 1
  v_bfe_i32 v122, v9, 18, 1
  v_bfe_i32 v126, v9, 2, 1
HOP78:
  s_cbranch_execz HOP94
  v_bfe_i32 v123, v9, 19, 1
  v_bfe_i32 v127, v9, 3, 1
  s_nop 3
  v_bfi_b32 v72, v120, v72, v10
  v_bfi_b32 v76, v124, v76, v10
  v_bfi_b32 v73, v121, v73, v10
  v_bfi_b32 v77, v125, v77, v10
  v_bfi_b32 v74, v122, v74, v10
  v_bfi_b32 v78, v126, v78, v10
  v_bfi_b32 v75, v123, v75, v10
  v_bfi_b32 v79, v127, v79, v10
  v_bfe_i32 v120, v8, 16, 1
  v_bfe_i32 v124, v8, 0, 1
  v_bfe_i32 v121, v8, 17, 1
  v_bfe_i32 v125, v8, 1, 1
  v_bfe_i32 v122, v8, 18, 1
  v_bfe_i32 v126, v8, 2, 1
  v_bfe_i32 v123, v8, 19, 1
  v_bfe_i32 v127, v8, 3, 1
  v_bfi_b32 v80, v120, v80, v10
  v_bfi_b32 v84, v124, v84, v10
  v_bfi_b32 v81, v121, v81, v10
  v_bfi_b32 v85, v125, v85, v10
  v_bfi_b32 v82, v122, v82, v10
  v_bfi_b32 v86, v126, v86, v10
  v_bfi_b32 v83, v123, v83, v10
  v_bfi_b32 v87, v127, v87, v10
  v_bfe_i32 v120, v8, 16, 1
  v_bfe_i32 v124, v8, 0, 1
  v_bfe_i32 v121, v8, 17, 1
  v_bfe_i32 v125, v8, 1, 1
HOP79:
  s_cbranch_execz HOP95
  v_bfe_i32 v122, v8, 18, 1
  v_bfe_i32 v126, v8, 2, 1
  v_bfe_i32 v123, v8, 19, 1
  v_bfe_i32 v127, v8, 3, 1
  v_bfi_b32 v88, v120, v88, v10
  v_bfi_b32 v92, v124, v92, v10
  v_bfi_b32 v89, v121, v89, v10
  v_bfi_b32 v93, v125, v93, v10
  v_bfi_b32 v90, v122, v90, v10
  v_bfi_b32 v94, v126, v94, v10
  v_bfi_b32 v91, v123, v91, v10
  v_bfi_b32 v95, v127, v95, v10
  v_bfe_i32 v120, v8, 16, 1
  v_bfe_i32 v124, v8, 0, 1
  v_bfe_i32 v121, v8, 17, 1
  v_bfe_i32 v125, v8, 1, 1
  v_bfe_i32 v122, v8, 18, 1
  v_bfe_i32 v126, v8, 2, 1
  v_bfe_i32 v123, v8, 19, 1
  v_bfe_i32 v127, v8, 3, 1
  v_bfi_b32 v96, v120, v96, v10
  v_bfi_b32 v100, v124, v100, v10
  v_bfi_b32 v97, v121, v97, v10
  v_bfi_b32 v101, v125, v101, v10
  v_bfi_b32 v98, v122, v98, v10
  v_bfi_b32 v102, v126, v102, v10
  v_bfi_b32 v99, v123, v99, v10
  v_bfi_b32 v103, v127, v103, v10
  v_max3_f32 v104, v72, v73, v74
  v_max3_f32 v105, v75, v76, v77
HOP80:
  s_cbranch_execz HOP96
  v_max3_f32 v108, v80, v81, v82
  v_max3_f32 v109, v83, v84, v85
  v_max3_f32 v112, v88, v89, v90
  v_max3_f32 v113, v91, v92, v93
  v_max3_f32 v116, v96, v97, v98
  v_max3_f32 v117, v99, v100, v101
  v_max3_f32 v104, v104, v78, v79
  v_max3_f32 v108, v108, v86, v87
  v_max3_f32 v112, v112, v94, v95
  v_max3_f32 v116, v116, v102, v103
  v_max_f32 v104, v104, v105
  v_max_f32 v108, v108, v109
  v_max_f32 v112, v112, v113
  v_max_f32 v116, v116, v117
  v_mov_b32 v105, v104
  v_mov_b32 v109, v108
  v_mov_b32 v113, v112
  v_mov_b32 v117, v116
  v_permlane32_swap_b32 v105, v104
  v_permlane32_swap_b32 v109, v108
  v_permlane32_swap_b32 v113, v112
  v_permlane32_swap_b32 v117, v116
  v_max_f32 v104, v104, v105
  v_max_f32 v108, v108, v109
  v_max_f32 v112, v112, v113
  v_max_f32 v116, v116, v117
  v_mov_b32 v105, v104
  v_mov_b32 v109, v108
  v_mov_b32 v113, v112
  v_mov_b32 v117, v116
  v_permlane16_swap_b32 v105, v104
  v_permlane16_swap_b32 v109, v108
  v_permlane16_swap_b32 v113, v112
  v_permlane16_swap_b32 v117, v116
  v_max_f32 v104, v104, v105
  v_max_f32 v108, v108, v109
  v_max_f32 v112, v112, v113
  v_max_f32 v116, v116, v117
  s_waitcnt lgkmcnt(10)
  v_mul_f32 v106, s78, v12
  v_mul_f32 v110, s78, v13
  v_mul_f32 v114, s78, v14
  v_mul_f32 v118, s78, v15
  v_mul_f32 v104, v106, v104
  v_mul_f32 v108, v110, v108
  v_mul_f32 v112, v114, v112
  v_mul_f32 v116, v118, v116
  v_pk_fma_f32 v[72:73], v[72:73], v[106:107], v[104:105] op_sel_hi:[1,0,0] neg_lo:[0,0,1] neg_hi:[0,0,1]
  v_pk_fma_f32 v[74:75], v[74:75], v[106:107], v[104:105] op_sel_hi:[1,0,0] neg_lo:[0,0,1] neg_hi:[0,0,1]
HOP81:
  s_cbranch_execz HOP97
  v_pk_fma_f32 v[76:77], v[76:77], v[106:107], v[104:105] op_sel_hi:[1,0,0] neg_lo:[0,0,1] neg_hi:[0,0,1]
  v_pk_fma_f32 v[78:79], v[78:79], v[106:107], v[104:105] op_sel_hi:[1,0,0] neg_lo:[0,0,1] neg_hi:[0,0,1]
  v_pk_fma_f32 v[80:81], v[80:81], v[110:111], v[108:109] op_sel_hi:[1,0,0] neg_lo:[0,0,1] neg_hi:[0,0,1]
  v_pk_fma_f32 v[82:83], v[82:83], v[110:111], v[108:109] op_sel_hi:[1,0,0] neg_lo:[0,0,1] neg_hi:[0,0,1]
  v_pk_fma_f32 v[84:85], v[84:85], v[110:111], v[108:109] op_sel_hi:[1,0,0] neg_lo:[0,0,1] neg_hi:[0,0,1]
  v_pk_fma_f32 v[86:87], v[86:87], v[110:111], v[108:109] op_sel_hi:[1,0,0] neg_lo:[0,0,1] neg_hi:[0,0,1]
  v_pk_fma_f32 v[88:89], v[88:89], v[114:115], v[112:113] op_sel_hi:[1,0,0] neg_lo:[0,0,1] neg_hi:[0,0,1]
  v_pk_fma_f32 v[90:91], v[90:91], v[114:115], v[112:113] op_sel_hi:[1,0,0] neg_lo:[0,0,1] neg_hi:[0,0,1]
  v_pk_fma_f32 v[92:93], v[92:93], v[114:115], v[112:113] op_sel_hi:[1,0,0] neg_lo:[0,0,1] neg_hi:[0,0,1]
  v_pk_fma_f32 v[94:95], v[94:95], v[114:115], v[112:113] op_sel_hi:[1,0,0] neg_lo:[0,0,1] neg_hi:[0,0,1]
  v_pk_fma_f32 v[96:97], v[96:97], v[118:119], v[116:117] op_sel_hi:[1,0,0] neg_lo:[0,0,1] neg_hi:[0,0,1]
  v_pk_fma_f32 v[98:99], v[98:99], v[118:119], v[116:117] op_sel_hi:[1,0,0] neg_lo:[0,0,1] neg_hi:[0,0,1]
  v_pk_fma_f32 v[100:101], v[100:101], v[118:119], v[116:117] op_sel_hi:[1,0,0] neg_lo:[0,0,1] neg_hi:[0,0,1]
  v_pk_fma_f32 v[102:103], v[102:103], v[118:119], v[116:117] op_sel_hi:[1,0,0] neg_lo:[0,0,1] neg_hi:[0,0,1]
  v_exp_f32 v72, v72
  v_exp_f32 v73, v73
  v_exp_f32 v74, v74
  v_exp_f32 v75, v75
  v_exp_f32 v76, v76
  v_exp_f32 v77, v77
  v_exp_f32 v78, v78
  v_exp_f32 v79, v79
  v_exp_f32 v80, v80
  v_exp_f32 v81, v81
  v_exp_f32 v82, v82
  v_exp_f32 v83, v83
  v_exp_f32 v84, v84
  v_exp_f32 v85, v85
  v_exp_f32 v86, v86
  v_exp_f32 v87, v87
  v_exp_f32 v88, v88
  v_exp_f32 v89, v89
  v_exp_f32 v90, v90
  v_exp_f32 v91, v91
  v_exp_f32 v92, v92
  v_exp_f32 v93, v93
  v_exp_f32 v94, v94
  v_exp_f32 v95, v95
  v_exp_f32 v96, v96
  v_exp_f32 v97, v97
  v_exp_f32 v98, v98
  v_exp_f32 v99, v99
  v_exp_f32 v100, v100
  v_exp_f32 v101, v101
  v_exp_f32 v102, v102
  v_exp_f32 v103, v103
HOP82:
  s_cbranch_execz HOP98
  v_pk_add_f32 v[104:105], v[72:73], v[74:75]
  v_pk_add_f32 v[106:107], v[76:77], v[78:79]
  v_pk_add_f32 v[108:109], v[80:81], v[82:83]
  v_pk_add_f32 v[110:111], v[84:85], v[86:87]
  v_pk_add_f32 v[112:113], v[88:89], v[90:91]
  v_pk_add_f32 v[114:115], v[92:93], v[94:95]
  v_pk_add_f32 v[116:117], v[96:97], v[98:99]
  v_pk_add_f32 v[118:119], v[100:101], v[102:103]
  v_cvt_pk_bf16_f32 v16, v76, v77
  v_cvt_pk_bf16_f32 v17, v78, v79
  v_cvt_pk_bf16_f32 v18, v72, v73
  v_cvt_pk_bf16_f32 v19, v74, v75
  v_cvt_pk_bf16_f32 v20, v84, v85
  v_cvt_pk_bf16_f32 v21, v86, v87
  v_cvt_pk_bf16_f32 v22, v80, v81
  v_cvt_pk_bf16_f32 v23, v82, v83
  v_cvt_pk_bf16_f32 v24, v92, v93
  v_cvt_pk_bf16_f32 v25, v94, v95
  v_cvt_pk_bf16_f32 v26, v88, v89
  v_cvt_pk_bf16_f32 v27, v90, v91
  v_cvt_pk_bf16_f32 v28, v100, v101
  v_cvt_pk_bf16_f32 v29, v102, v103
  v_cvt_pk_bf16_f32 v30, v96, v97
  v_cvt_pk_bf16_f32 v31, v98, v99
  v_pk_add_f32 v[104:105], v[104:105], v[106:107]
  v_pk_add_f32 v[108:109], v[108:109], v[110:111]
  v_pk_add_f32 v[112:113], v[112:113], v[114:115]
  v_pk_add_f32 v[116:117], v[116:117], v[118:119]
  s_waitcnt lgkmcnt(0)
  v_mfma_f32_16x16x32_bf16 v[128:131], v[52:55], v[16:19], 0
  v_mfma_f32_16x16x32_bf16 v[132:135], v[62:65], v[16:19], 0
HOP83:
  s_cbranch_execz HOP99
  v_mfma_f32_16x16x32_bf16 v[136:139], v[54:57], v[20:23], 0
  v_mfma_f32_16x16x32_bf16 v[140:143], v[64:67], v[20:23], 0
  v_mfma_f32_16x16x32_bf16 v[144:147], v[56:59], v[24:27], 0
  v_mfma_f32_16x16x32_bf16 v[148:151], v[66:69], v[24:27], 0
  v_mfma_f32_16x16x32_bf16 v[152:155], v[58:61], v[28:31], 0
  v_mfma_f32_16x16x32_bf16 v[156:159], v[68:71], v[28:31], 0
  v_add_f32 v104, v104, v105
  v_add_f32 v108, v108, v109
  v_add_f32 v112, v112, v113
  v_add_f32 v116, v116, v117
  v_mov_b32 v105, v104
  v_mov_b32 v109, v108
  v_mov_b32 v113, v112
  v_mov_b32 v117, v116
  v_permlane32_swap_b32 v105, v104
  v_permlane32_swap_b32 v109, v108
  v_permlane32_swap_b32 v113, v112
  v_permlane32_swap_b32 v117, v116
  v_add_f32 v104, v104, v105
  v_add_f32 v108, v108, v109
  v_add_f32 v112, v112, v113
  v_add_f32 v116, v116, v117
  v_mov_b32 v105, v104
  v_mov_b32 v109, v108
  v_mov_b32 v113, v112
  v_mov_b32 v117, v116
  v_permlane16_swap_b32 v105, v104
  v_permlane16_swap_b32 v109, v108
  v_permlane16_swap_b32 v113, v112
  v_permlane16_swap_b32 v117, v116
  v_add_f32 v104, v104, v105
  v_add_f32 v108, v108, v109
  v_add_f32 v112, v112, v113
  v_add_f32 v116, v116, v117
  v_rcp_f32 v104, v104
  v_rcp_f32 v108, v108
  v_rcp_f32 v112, v112
  v_rcp_f32 v116, v116
  s_lshl_b32 s53, s45, 3
  s_add_u32 s53, s53, s77
  s_mul_i32 s53, s53, 72
  s_lshl_b32 s54, s47, 1
  s_add_u32 s53, s53, s54
  s_add_u32 s53, s53, s76
  s_lshl_b32 s53, s53, 10
  v_cmp_gt_u32 vcc, 48, v0
  v_pk_mul_f32 v[128:129], v[104:105], v[128:129] op_sel:[0,0] op_sel_hi:[0,1]
  v_pk_mul_f32 v[130:131], v[104:105], v[130:131] op_sel:[0,0] op_sel_hi:[0,1]
  v_pk_mul_f32 v[132:133], v[104:105], v[132:133] op_sel:[0,0] op_sel_hi:[0,1]
  v_pk_mul_f32 v[134:135], v[104:105], v[134:135] op_sel:[0,0] op_sel_hi:[0,1]
HOP84:
  s_cbranch_execz L_hopret
  v_cvt_pk_bf16_f32 v72, v128, v129
  v_cvt_pk_bf16_f32 v73, v130, v131
  v_cvt_pk_bf16_f32 v74, v132, v133
  v_cvt_pk_bf16_f32 v75, v134, v135
  v_cndmask_b32 v74, 0, v74, vcc
  v_cndmask_b32 v75, 0, v75, vcc
  s_add_u32 s54, s53, 0
  buffer_store_dwordx4 v[72:75], v1, s[40:43], s54 offen sc1
  v_pk_mul_f32 v[136:137], v[108:109], v[136:137] op_sel:[0,0] op_sel_hi:[0,1]
  v_pk_mul_f32 v[138:139], v[108:109], v[138:139] op_sel:[0,0] op_sel_hi:[0,1]
  v_pk_mul_f32 v[140:141], v[108:109], v[140:141] op_sel:[0,0] op_sel_hi:[0,1]
  v_pk_mul_f32 v[142:143], v[108:109], v[142:143] op_sel:[0,0] op_sel_hi:[0,1]
  v_cvt_pk_bf16_f32 v80, v136, v137
  v_cvt_pk_bf16_f32 v81, v138, v139
  v_cvt_pk_bf16_f32 v82, v140, v141
  v_cvt_pk_bf16_f32 v83, v142, v143
  v_cndmask_b32 v82, 0, v82, vcc
  v_cndmask_b32 v83, 0, v83, vcc
  s_add_u32 s54, s53, 73728
  buffer_store_dwordx4 v[80:83], v1, s[40:43], s54 offen sc1
  v_pk_mul_f32 v[144:145], v[112:113], v[144:145] op_sel:[0,0] op_sel_hi:[0,1]
  v_pk_mul_f32 v[146:147], v[112:113], v[146:147] op_sel:[0,0] op_sel_hi:[0,1]
  v_pk_mul_f32 v[148:149], v[112:113], v[148:149] op_sel:[0,0] op_sel_hi:[0,1]
  v_pk_mul_f32 v[150:151], v[112:113], v[150:151] op_sel:[0,0] op_sel_hi:[0,1]
  v_cvt_pk_bf16_f32 v88, v144, v145
  v_cvt_pk_bf16_f32 v89, v146, v147
  v_cvt_pk_bf16_f32 v90, v148, v149
  v_cvt_pk_bf16_f32 v91, v150, v151
  v_cndmask_b32 v90, 0, v90, vcc
  v_cndmask_b32 v91, 0, v91, vcc
  s_add_u32 s54, s53, 147456
  buffer_store_dwordx4 v[88:91], v1, s[40:43], s54 offen sc1
  v_pk_mul_f32 v[152:153], v[116:117], v[152:153] op_sel:[0,0] op_sel_hi:[0,1]
  v_pk_mul_f32 v[154:155], v[116:117], v[154:155] op_sel:[0,0] op_sel_hi:[0,1]
HOP85:
  s_cbranch_execz L_hopret
  v_pk_mul_f32 v[156:157], v[116:117], v[156:157] op_sel:[0,0] op_sel_hi:[0,1]
  v_pk_mul_f32 v[158:159], v[116:117], v[158:159] op_sel:[0,0] op_sel_hi:[0,1]
  v_cvt_pk_bf16_f32 v96, v152, v153
  v_cvt_pk_bf16_f32 v97, v154, v155
  v_cvt_pk_bf16_f32 v98, v156, v157
  v_cvt_pk_bf16_f32 v99, v158, v159
  v_cndmask_b32 v98, 0, v98, vcc
  v_cndmask_b32 v99, 0, v99, vcc
  s_add_u32 s54, s53, 221184
  buffer_store_dwordx4 v[96:99], v1, s[40:43], s54 offen sc1
  s_cmp_lt_u32 s66, 28
  s_cbranch_scc1 L_hp
  s_waitcnt vmcnt(0)
  s_branch L_hp2
L_hp:
  v_lshlrev_b32 v15, 4, v0
  s_add_u32 s56, s81, 0
  buffer_load_dwordx4 v[112:115], v15, s[40:43], s56 offen offset:0 sc1
  buffer_load_dwordx4 v[116:119], v15, s[40:43], s56 offen offset:1024 sc1
  buffer_load_dwordx4 v[120:123], v15, s[40:43], s56 offen offset:2048 sc1
  buffer_load_dwordx4 v[124:127], v15, s[40:43], s56 offen offset:3072 sc1
  s_add_u32 s56, s81, 4096
  buffer_load_dwordx4 v[128:131], v15, s[40:43], s56 offen offset:0 sc1
  buffer_load_dwordx4 v[132:135], v15, s[40:43], s56 offen offset:1024 sc1
  buffer_load_dwordx4 v[136:139], v15, s[40:43], s56 offen offset:2048 sc1
  buffer_load_dwordx4 v[140:143], v15, s[40:43], s56 offen offset:3072 sc1
  s_add_u32 s56, s81, 65536
  buffer_load_dwordx4 v[144:147], v15, s[40:43], s56 offen offset:0 sc1
  buffer_load_dwordx4 v[148:151], v15, s[40:43], s56 offen offset:1024 sc1
  buffer_load_dwordx4 v[152:155], v15, s[40:43], s56 offen offset:2048 sc1
  buffer_load_dwordx4 v[156:159], v15, s[40:43], s56 offen offset:3072 sc1
  s_add_u32 s56, s81, 69632
  buffer_load_dwordx4 v[160:163], v15, s[40:43], s56 offen offset:0 sc1
  buffer_load_dwordx4 v[164:167], v15, s[40:43], s56 offen offset:1024 sc1
  buffer_load_dwordx4 v[168:171], v15, s[40:43], s56 offen offset:2048 sc1
HOP86:
  s_cbranch_execz L_hopret
  buffer_load_dwordx4 v[172:175], v15, s[40:43], s56 offen offset:3072 sc1
  s_waitcnt vmcnt(16)
L_hp2:
  v_mov_b32 v2, 152964
  v_mov_b32 v3, 1
  v_cmp_eq_u32 vcc, 0, v0
  s_nop 0
  s_and_saveexec_b64 s[74:75], vcc
  ds_add_rtn_u32 v3, v2, v3
  s_waitcnt lgkmcnt(0)
  s_mov_b64 exec, s[74:75]
  v_readfirstlane_b32 s54, v3
  s_bitcmp1_b32 s46, 0
  s_cselect_b32 s55, 3, 7
  s_cmp_eq_u32 s54, s55
  s_cbranch_scc0 L_pubh
  s_lshl_b32 s53, s45, 4
  s_add_u32 s53, s53, s46
  s_lshl_b32 s53, s53, 7
  s_add_u32 s53, s53, 11960320
  v_mov_b32 v1, s53
  v_mov_b32 v2, s67
  v_cmp_eq_u32 vcc, 0, v0
  s_nop 0
  s_and_saveexec_b64 s[74:75], vcc
  buffer_store_dword v2, v1, s[40:43], 0 offen sc1
  s_mov_b64 exec, s[74:75]
L_pubh:
L_thq:
  s_cmp_lt_u32 s66, 28
  s_cbranch_scc0 L_fin
L_k2:
  s_barrier
  v_lshlrev_b32 v15, 4, v0
  s_mov_b32 s24, s4
  s_mov_b32 s25, s5
  s_mov_b32 s26, 1835008
  s_mov_b32 s27, 0x20000
  s_mov_b32 s28, s18
  s_mov_b32 s29, s19
  s_mov_b32 s30, 1835008
  s_mov_b32 s31, 0x20000
  v_lshrrev_b32 v1, 4, v0
  s_lshl_b32 s53, s64, 6
  s_lshl_b32 s54, s44, 2
  s_add_u32 s53, s53, s54
  v_add_u32 v1, s53, v1
  v_mul_u32_u24 v1, 896, v1
  v_and_b32 v2, 15, v0
  v_lshlrev_b32 v2, 3, v2
  s_lshl_b32 s53, s65, 7
  v_add3_u32 v14, v1, v2, s53
  s_mov_b32 s83, 28672
HOP87:
  s_cbranch_execz L_hopret
  s_lshl_b32 s53, s64, 2
  s_mul_i32 s53, s53, 72
  s_mul_i32 s54, s61, 5
  s_add_u32 s54, s54, 32
  s_add_u32 s54, s54, s53
  s_lshl_b32 s84, s54, 10
  s_lshl_b32 s54, s61, 1
  s_add_u32 s54, s54, s53
  s_lshl_b32 s85, s54, 10
  s_lshr_b32 s53, s64, 1
  s_lshl_b32 s53, s53, 4
  s_lshl_b32 s54, s61, 1
  s_add_u32 s53, s53, s54
  s_lshl_b32 s53, s53, 7
  s_add_u32 s87, s53, 11960320
  v_mov_b32 v3, s87
  v_lshlrev_b32 v9, 3, v0
  v_and_b32 v1, 15, v0
  v_mul_u32_u24 v1, 272, v1
  v_lshrrev_b32 v2, 4, v0
  v_lshlrev_b32 v2, 4, v2
  s_mul_i32 s53, s44, 17408
  v_add3_u32 v8, v1, v2, s53
  s_mov_b32 s53, 0
  buffer_load_dword v4, v3, s[40:43], 0 offen offset:128 sc1
  s_sleep 2
  buffer_load_dword v5, v3, s[40:43], 0 offen offset:128 sc1
  s_sleep 2
L_pq:
  buffer_load_dword v6, v3, s[40:43], 0 offen offset:128 sc1
  s_waitcnt vmcnt(2)
  v_readfirstlane_b32 s54, v4
  s_add_u32 s53, s53, 1
  s_cmp_eq_u32 s54, s67
  s_cbranch_scc1 L_pq_d
  s_sleep 2
  buffer_load_dword v4, v3, s[40:43], 0 offen offset:128 sc1
  s_waitcnt vmcnt(2)
  v_readfirstlane_b32 s54, v5
  s_add_u32 s53, s53, 1
  s_cmp_eq_u32 s54, s67
  s_cbranch_scc1 L_pq_d
  s_sleep 2
  buffer_load_dword v5, v3, s[40:43], 0 offen offset:128 sc1
  s_waitcnt vmcnt(2)
  v_readfirstlane_b32 s54, v6
  s_add_u32 s53, s53, 1
  s_cmp_eq_u32 s54, s67
  s_cbranch_scc1 L_pq_d
  s_sleep 2
  s_cmp_lt_u32 s53, 0x18000
HOP88:
  s_cbranch_execz L_hopret
  s_cbranch_scc1 L_pq
L_pq_d:
  s_add_u32 s56, s84, 0
  buffer_load_dwordx4 v[80:83], v15, s[40:43], s56 offen sc1
  s_add_u32 s56, s84, 1024
  buffer_load_dwordx4 v[84:87], v15, s[40:43], s56 offen sc1
  s_add_u32 s56, s84, 2048
  buffer_load_dwordx2 v[88:89], v9, s[40:43], s56 offen sc1
  buffer_load_dwordx2 v[90:91], v9, s[40:43], s56 offen offset:512 sc1
  s_add_u32 s56, s84, 3072
  buffer_load_dwordx4 v[92:95], v15, s[40:43], s56 offen sc1
  s_add_u32 s56, s84, 4096
  buffer_load_dwordx4 v[96:99], v15, s[40:43], s56 offen sc1
  s_add_u32 s56, s84, 73728
  buffer_load_dwordx4 v[100:103], v15, s[40:43], s56 offen sc1
  s_add_u32 s56, s84, 74752
  buffer_load_dwordx4 v[104:107], v15, s[40:43], s56 offen sc1
  s_add_u32 s56, s84, 75776
  buffer_load_dwordx2 v[108:109], v9, s[40:43], s56 offen sc1
  buffer_load_dwordx2 v[110:111], v9, s[40:43], s56 offen offset:512 sc1
  s_waitcnt vmcnt(8)
  v_mfma_f32_16x16x32_bf16 v[16:19], v[176:179], v[80:83], 0
  v_mfma_f32_16x16x32_bf16 v[16:19], v[192:195], v[84:87], v[16:19]
  v_mfma_f32_16x16x32_bf16 v[20:23], v[180:183], v[80:83], 0
  v_mfma_f32_16x16x32_bf16 v[20:23], v[196:199], v[84:87], v[20:23]
  v_mfma_f32_16x16x32_bf16 v[24:27], v[184:187], v[80:83], 0
  v_mfma_f32_16x16x32_bf16 v[24:27], v[200:203], v[84:87], v[24:27]
  v_mfma_f32_16x16x32_bf16 v[28:31], v[188:191], v[80:83], 0
  v_mfma_f32_16x16x32_bf16 v[28:31], v[204:207], v[84:87], v[28:31]
  s_add_u32 s56, s84, 76800
  buffer_load_dwordx4 v[80:83], v15, s[40:43], s56 offen sc1
  s_add_u32 s56, s84, 77824
  buffer_load_dwordx4 v[84:87], v15, s[40:43], s56 offen sc1
HOP89:
  s_cbranch_execz L_hopret
  s_waitcnt vmcnt(7)
  v_mfma_f32_16x16x32_bf16 v[16:19], v[208:211], v[88:91], v[16:19]
  v_mfma_f32_16x16x32_bf16 v[16:19], v[224:227], v[92:95], v[16:19]
  v_mfma_f32_16x16x32_bf16 v[20:23], v[212:215], v[88:91], v[20:23]
  v_mfma_f32_16x16x32_bf16 v[20:23], v[228:231], v[92:95], v[20:23]
  v_mfma_f32_16x16x32_bf16 v[24:27], v[216:219], v[88:91], v[24:27]
  v_mfma_f32_16x16x32_bf16 v[24:27], v[232:235], v[92:95], v[24:27]
  v_mfma_f32_16x16x32_bf16 v[28:31], v[220:223], v[88:91], v[28:31]
  v_mfma_f32_16x16x32_bf16 v[28:31], v[236:239], v[92:95], v[28:31]
  s_add_u32 s56, s84, 147456
  buffer_load_dwordx4 v[88:91], v15, s[40:43], s56 offen sc1
  s_add_u32 s56, s84, 148480
  buffer_load_dwordx4 v[92:95], v15, s[40:43], s56 offen sc1
  s_waitcnt vmcnt(8)
  v_mfma_f32_16x16x32_bf16 v[16:19], v[240:243], v[96:99], v[16:19]
  v_mfma_f32_16x16x32_bf16 v[20:23], v[244:247], v[96:99], v[20:23]
  v_mfma_f32_16x16x32_bf16 v[24:27], v[248:251], v[96:99], v[24:27]
  v_mfma_f32_16x16x32_bf16 v[28:31], v[252:255], v[96:99], v[28:31]
  s_add_u32 s56, s84, 149504
  buffer_load_dwordx2 v[96:97], v9, s[40:43], s56 offen sc1
  buffer_load_dwordx2 v[98:99], v9, s[40:43], s56 offen offset:512 sc1
  s_waitcnt vmcnt(8)
  v_mfma_f32_16x16x32_bf16 v[32:35], v[176:179], v[100:103], 0
  v_mfma_f32_16x16x32_bf16 v[32:35], v[192:195], v[104:107], v[32:35]
  v_mfma_f32_16x16x32_bf16 v[36:39], v[180:183], v[100:103], 0
  v_mfma_f32_16x16x32_bf16 v[36:39], v[196:199], v[104:107], v[36:39]
  v_mfma_f32_16x16x32_bf16 v[40:43], v[184:187], v[100:103], 0
  v_mfma_f32_16x16x32_bf16 v[40:43], v[200:203], v[104:107], v[40:43]
  v_mfma_f32_16x16x32_bf16 v[44:47], v[188:191], v[100:103], 0
  v_mfma_f32_16x16x32_bf16 v[44:47], v[204:207], v[104:107], v[44:47]
  s_add_u32 s56, s84, 150528
  buffer_load_dwordx4 v[100:103], v15, s[40:43], s56 offen sc1
HOP90:
  s_cbranch_execz L_hopret
  s_add_u32 s56, s84, 151552
  buffer_load_dwordx4 v[104:107], v15, s[40:43], s56 offen sc1
  s_waitcnt vmcnt(7)
  v_mfma_f32_16x16x32_bf16 v[32:35], v[208:211], v[108:111], v[32:35]
  v_mfma_f32_16x16x32_bf16 v[32:35], v[224:227], v[80:83], v[32:35]
  v_mfma_f32_16x16x32_bf16 v[36:39], v[212:215], v[108:111], v[36:39]
  v_mfma_f32_16x16x32_bf16 v[36:39], v[228:231], v[80:83], v[36:39]
  v_mfma_f32_16x16x32_bf16 v[40:43], v[216:219], v[108:111], v[40:43]
  v_mfma_f32_16x16x32_bf16 v[40:43], v[232:235], v[80:83], v[40:43]
  v_mfma_f32_16x16x32_bf16 v[44:47], v[220:223], v[108:111], v[44:47]
  v_mfma_f32_16x16x32_bf16 v[44:47], v[236:239], v[80:83], v[44:47]
  buffer_load_dword v7, v3, s[40:43], 0 offen sc1
  s_add_u32 s56, s84, 221184
  buffer_load_dwordx4 v[108:111], v15, s[40:43], s56 offen sc1
  s_add_u32 s56, s84, 222208
  buffer_load_dwordx4 v[80:83], v15, s[40:43], s56 offen sc1
  s_waitcnt vmcnt(9)
  v_mfma_f32_16x16x32_bf16 v[32:35], v[240:243], v[84:87], v[32:35]
  v_mfma_f32_16x16x32_bf16 v[36:39], v[244:247], v[84:87], v[36:39]
  v_mfma_f32_16x16x32_bf16 v[40:43], v[248:251], v[84:87], v[40:43]
  v_mfma_f32_16x16x32_bf16 v[44:47], v[252:255], v[84:87], v[44:47]
  s_add_u32 s56, s84, 223232
  buffer_load_dwordx2 v[84:85], v9, s[40:43], s56 offen sc1
  buffer_load_dwordx2 v[86:87], v9, s[40:43], s56 offen offset:512 sc1
  s_waitcnt vmcnt(9)
  v_mfma_f32_16x16x32_bf16 v[48:51], v[176:179], v[88:91], 0
  v_mfma_f32_16x16x32_bf16 v[48:51], v[192:195], v[92:95], v[48:51]
  v_mfma_f32_16x16x32_bf16 v[52:55], v[180:183], v[88:91], 0
  v_mfma_f32_16x16x32_bf16 v[52:55], v[196:199], v[92:95], v[52:55]
  v_mfma_f32_16x16x32_bf16 v[56:59], v[184:187], v[88:91], 0
  v_mfma_f32_16x16x32_bf16 v[56:59], v[200:203], v[92:95], v[56:59]
  v_mfma_f32_16x16x32_bf16 v[60:63], v[188:191], v[88:91], 0
HOP91:
  s_cbranch_execz L_hopret
  v_mfma_f32_16x16x32_bf16 v[60:63], v[204:207], v[92:95], v[60:63]
  s_add_u32 s56, s84, 224256
  buffer_load_dwordx4 v[88:91], v15, s[40:43], s56 offen sc1
  s_add_u32 s56, s84, 225280
  buffer_load_dwordx4 v[92:95], v15, s[40:43], s56 offen sc1
  s_waitcnt vmcnt(8)
  v_mfma_f32_16x16x32_bf16 v[48:51], v[208:211], v[96:99], v[48:51]
  v_mfma_f32_16x16x32_bf16 v[48:51], v[224:227], v[100:103], v[48:51]
  v_mfma_f32_16x16x32_bf16 v[52:55], v[212:215], v[96:99], v[52:55]
  v_mfma_f32_16x16x32_bf16 v[52:55], v[228:231], v[100:103], v[52:55]
  v_mfma_f32_16x16x32_bf16 v[56:59], v[216:219], v[96:99], v[56:59]
  v_mfma_f32_16x16x32_bf16 v[56:59], v[232:235], v[100:103], v[56:59]
  v_mfma_f32_16x16x32_bf16 v[60:63], v[220:223], v[96:99], v[60:63]
  v_mfma_f32_16x16x32_bf16 v[60:63], v[236:239], v[100:103], v[60:63]
  s_waitcnt vmcnt(6)
  v_readfirstlane_b32 s54, v7
  s_nop 0
  s_cmp_eq_u32 s54, s67
  s_cbranch_scc1 L_pp_d
  s_mov_b32 s53, 0
  buffer_load_dword v4, v3, s[40:43], 0 offen offset:0 sc1
  s_sleep 2
  buffer_load_dword v5, v3, s[40:43], 0 offen offset:0 sc1
  s_sleep 2
L_pp:
  buffer_load_dword v6, v3, s[40:43], 0 offen offset:0 sc1
  s_waitcnt vmcnt(2)
  v_readfirstlane_b32 s54, v4
  s_add_u32 s53, s53, 1
  s_cmp_eq_u32 s54, s67
  s_cbranch_scc1 L_pp_d
  s_sleep 2
  buffer_load_dword v4, v3, s[40:43], 0 offen offset:0 sc1
  s_waitcnt vmcnt(2)
  v_readfirstlane_b32 s54, v5
  s_add_u32 s53, s53, 1
  s_cmp_eq_u32 s54, s67
  s_cbranch_scc1 L_pp_d
  s_sleep 2
  buffer_load_dword v5, v3, s[40:43], 0 offen offset:0 sc1
  s_waitcnt vmcnt(2)
  v_readfirstlane_b32 s54, v6
  s_add_u32 s53, s53, 1
HOP92:
  s_cbranch_execz L_hopret
  s_cmp_eq_u32 s54, s67
  s_cbranch_scc1 L_pp_d
  s_sleep 2
  s_cmp_lt_u32 s53, 0x18000
  s_cbranch_scc1 L_pp
L_pp_d:
  s_add_u32 s56, s85, 0
  buffer_load_dwordx4 v[96:99], v15, s[40:43], s56 offen sc1
  s_add_u32 s56, s85, 1024
  buffer_load_dwordx4 v[100:103], v15, s[40:43], s56 offen sc1
  v_mfma_f32_16x16x32_bf16 v[48:51], v[240:243], v[104:107], v[48:51]
  v_mfma_f32_16x16x32_bf16 v[52:55], v[244:247], v[104:107], v[52:55]
  v_mfma_f32_16x16x32_bf16 v[56:59], v[248:251], v[104:107], v[56:59]
  v_mfma_f32_16x16x32_bf16 v[60:63], v[252:255], v[104:107], v[60:63]
  s_add_u32 s56, s85, 16384
  buffer_load_dwordx4 v[104:107], v15, s[40:43], s56 offen sc1
  s_waitcnt vmcnt(7)
  v_mfma_f32_16x16x32_bf16 v[64:67], v[176:179], v[108:111], 0
  v_mfma_f32_16x16x32_bf16 v[64:67], v[192:195], v[80:83], v[64:67]
  v_mfma_f32_16x16x32_bf16 v[68:71], v[180:183], v[108:111], 0
  v_mfma_f32_16x16x32_bf16 v[68:71], v[196:199], v[80:83], v[68:71]
  v_mfma_f32_16x16x32_bf16 v[72:75], v[184:187], v[108:111], 0
  v_mfma_f32_16x16x32_bf16 v[72:75], v[200:203], v[80:83], v[72:75]
  v_mfma_f32_16x16x32_bf16 v[76:79], v[188:191], v[108:111], 0
  v_mfma_f32_16x16x32_bf16 v[76:79], v[204:207], v[80:83], v[76:79]
  s_add_u32 s56, s85, 17408
  buffer_load_dwordx4 v[108:111], v15, s[40:43], s56 offen sc1
  buffer_load_dwordx2 v[10:11], v14, s[24:27], 0 offen
  buffer_load_dwordx2 v[12:13], v14, s[24:27], s83 offen
  s_add_u32 s56, s85, 73728
  buffer_load_dwordx4 v[80:83], v15, s[40:43], s56 offen sc1
  s_waitcnt vmcnt(8)
  v_mfma_f32_16x16x32_bf16 v[64:67], v[208:211], v[84:87], v[64:67]
  v_mfma_f32_16x16x32_bf16 v[64:67], v[224:227], v[88:91], v[64:67]
  v_mfma_f32_16x16x32_bf16 v[68:71], v[212:215], v[84:87], v[68:71]
HOP93:
  s_cbranch_execz L_hopret
  v_mfma_f32_16x16x32_bf16 v[68:71], v[228:231], v[88:91], v[68:71]
  v_mfma_f32_16x16x32_bf16 v[72:75], v[216:219], v[84:87], v[72:75]
  v_mfma_f32_16x16x32_bf16 v[72:75], v[232:235], v[88:91], v[72:75]
  v_mfma_f32_16x16x32_bf16 v[76:79], v[220:223], v[84:87], v[76:79]
  v_mfma_f32_16x16x32_bf16 v[76:79], v[236:239], v[88:91], v[76:79]
  s_add_u32 s56, s85, 74752
  buffer_load_dwordx4 v[84:87], v15, s[40:43], s56 offen sc1
  s_add_u32 s56, s85, 90112
  buffer_load_dwordx4 v[88:91], v15, s[40:43], s56 offen sc1
  s_waitcnt vmcnt(9)
  v_mfma_f32_16x16x32_bf16 v[64:67], v[240:243], v[92:95], v[64:67]
  v_mfma_f32_16x16x32_bf16 v[68:71], v[244:247], v[92:95], v[68:71]
  v_mfma_f32_16x16x32_bf16 v[72:75], v[248:251], v[92:95], v[72:75]
  v_mfma_f32_16x16x32_bf16 v[76:79], v[252:255], v[92:95], v[76:79]
  s_add_u32 s56, s85, 91136
  buffer_load_dwordx4 v[92:95], v15, s[40:43], s56 offen sc1
  s_waitcnt vmcnt(8)
  v_mfma_f32_16x16x32_bf16 v[16:19], v[112:115], v[96:99], v[16:19]
  v_mfma_f32_16x16x32_bf16 v[16:19], v[128:131], v[100:103], v[16:19]
  v_mfma_f32_16x16x32_bf16 v[20:23], v[116:119], v[96:99], v[20:23]
  v_mfma_f32_16x16x32_bf16 v[20:23], v[132:135], v[100:103], v[20:23]
  v_mfma_f32_16x16x32_bf16 v[24:27], v[120:123], v[96:99], v[24:27]
  v_mfma_f32_16x16x32_bf16 v[24:27], v[136:139], v[100:103], v[24:27]
  v_mfma_f32_16x16x32_bf16 v[28:31], v[124:127], v[96:99], v[28:31]
  v_mfma_f32_16x16x32_bf16 v[28:31], v[140:143], v[100:103], v[28:31]
  s_add_u32 s56, s85, 147456
  buffer_load_dwordx4 v[96:99], v15, s[40:43], s56 offen sc1
  s_add_u32 s56, s85, 148480
  buffer_load_dwordx4 v[100:103], v15, s[40:43], s56 offen sc1
  s_waitcnt vmcnt(8)
  v_mfma_f32_16x16x32_bf16 v[16:19], v[144:147], v[104:107], v[16:19]
  v_mfma_f32_16x16x32_bf16 v[16:19], v[160:163], v[108:111], v[16:19]
HOP94:
  s_cbranch_execz L_hopret
  v_mfma_f32_16x16x32_bf16 v[20:23], v[148:151], v[104:107], v[20:23]
  v_mfma_f32_16x16x32_bf16 v[20:23], v[164:167], v[108:111], v[20:23]
  v_mfma_f32_16x16x32_bf16 v[24:27], v[152:155], v[104:107], v[24:27]
  v_mfma_f32_16x16x32_bf16 v[24:27], v[168:171], v[108:111], v[24:27]
  v_mfma_f32_16x16x32_bf16 v[28:31], v[156:159], v[104:107], v[28:31]
  v_mfma_f32_16x16x32_bf16 v[28:31], v[172:175], v[108:111], v[28:31]
  s_add_u32 s56, s85, 163840
  buffer_load_dwordx4 v[104:107], v15, s[40:43], s56 offen sc1
  s_add_u32 s56, s85, 164864
  buffer_load_dwordx4 v[108:111], v15, s[40:43], s56 offen sc1
  s_waitcnt vmcnt(6)
  v_mfma_f32_16x16x32_bf16 v[32:35], v[112:115], v[80:83], v[32:35]
  v_mfma_f32_16x16x32_bf16 v[32:35], v[128:131], v[84:87], v[32:35]
  v_mfma_f32_16x16x32_bf16 v[36:39], v[116:119], v[80:83], v[36:39]
  v_mfma_f32_16x16x32_bf16 v[36:39], v[132:135], v[84:87], v[36:39]
  v_mfma_f32_16x16x32_bf16 v[40:43], v[120:123], v[80:83], v[40:43]
  v_mfma_f32_16x16x32_bf16 v[40:43], v[136:139], v[84:87], v[40:43]
  v_mfma_f32_16x16x32_bf16 v[44:47], v[124:127], v[80:83], v[44:47]
  v_mfma_f32_16x16x32_bf16 v[44:47], v[140:143], v[84:87], v[44:47]
  s_add_u32 s56, s85, 221184
  buffer_load_dwordx4 v[80:83], v15, s[40:43], s56 offen sc1
  s_add_u32 s56, s85, 222208
  buffer_load_dwordx4 v[84:87], v15, s[40:43], s56 offen sc1
  ds_write_b128 v8, v[16:19] offset:0
  ds_write_b128 v8, v[20:23] offset:64
  s_waitcnt vmcnt(6)
  v_mfma_f32_16x16x32_bf16 v[32:35], v[144:147], v[88:91], v[32:35]
  v_mfma_f32_16x16x32_bf16 v[32:35], v[160:163], v[92:95], v[32:35]
  v_mfma_f32_16x16x32_bf16 v[36:39], v[148:151], v[88:91], v[36:39]
  v_mfma_f32_16x16x32_bf16 v[36:39], v[164:167], v[92:95], v[36:39]
  v_mfma_f32_16x16x32_bf16 v[40:43], v[152:155], v[88:91], v[40:43]
HOP95:
  s_cbranch_execz L_hopret
  v_mfma_f32_16x16x32_bf16 v[40:43], v[168:171], v[92:95], v[40:43]
  v_mfma_f32_16x16x32_bf16 v[44:47], v[156:159], v[88:91], v[44:47]
  v_mfma_f32_16x16x32_bf16 v[44:47], v[172:175], v[92:95], v[44:47]
  s_add_u32 s56, s85, 237568
  buffer_load_dwordx4 v[88:91], v15, s[40:43], s56 offen sc1
  s_add_u32 s56, s85, 238592
  buffer_load_dwordx4 v[92:95], v15, s[40:43], s56 offen sc1
  ds_write_b128 v8, v[24:27] offset:128
  ds_write_b128 v8, v[28:31] offset:192
  s_waitcnt vmcnt(6)
  v_mfma_f32_16x16x32_bf16 v[48:51], v[112:115], v[96:99], v[48:51]
  v_mfma_f32_16x16x32_bf16 v[48:51], v[128:131], v[100:103], v[48:51]
  v_mfma_f32_16x16x32_bf16 v[52:55], v[116:119], v[96:99], v[52:55]
  v_mfma_f32_16x16x32_bf16 v[52:55], v[132:135], v[100:103], v[52:55]
  v_mfma_f32_16x16x32_bf16 v[56:59], v[120:123], v[96:99], v[56:59]
  v_mfma_f32_16x16x32_bf16 v[56:59], v[136:139], v[100:103], v[56:59]
  v_mfma_f32_16x16x32_bf16 v[60:63], v[124:127], v[96:99], v[60:63]
  v_mfma_f32_16x16x32_bf16 v[60:63], v[140:143], v[100:103], v[60:63]
  ds_write_b128 v8, v[32:35] offset:4352
  ds_write_b128 v8, v[36:39] offset:4416
  s_waitcnt vmcnt(4)
  v_mfma_f32_16x16x32_bf16 v[48:51], v[144:147], v[104:107], v[48:51]
  v_mfma_f32_16x16x32_bf16 v[48:51], v[160:163], v[108:111], v[48:51]
  v_mfma_f32_16x16x32_bf16 v[52:55], v[148:151], v[104:107], v[52:55]
  v_mfma_f32_16x16x32_bf16 v[52:55], v[164:167], v[108:111], v[52:55]
  v_mfma_f32_16x16x32_bf16 v[56:59], v[152:155], v[104:107], v[56:59]
  v_mfma_f32_16x16x32_bf16 v[56:59], v[168:171], v[108:111], v[56:59]
  v_mfma_f32_16x16x32_bf16 v[60:63], v[156:159], v[104:107], v[60:63]
  v_mfma_f32_16x16x32_bf16 v[60:63], v[172:175], v[108:111], v[60:63]
  ds_write_b128 v8, v[40:43] offset:4480
  ds_write_b128 v8, v[44:47] offset:4544
HOP96:
  s_cbranch_execz L_hopret
  s_waitcnt vmcnt(2)
  v_mfma_f32_16x16x32_bf16 v[64:67], v[112:115], v[80:83], v[64:67]
  v_mfma_f32_16x16x32_bf16 v[64:67], v[128:131], v[84:87], v[64:67]
  v_mfma_f32_16x16x32_bf16 v[68:71], v[116:119], v[80:83], v[68:71]
  v_mfma_f32_16x16x32_bf16 v[68:71], v[132:135], v[84:87], v[68:71]
  v_mfma_f32_16x16x32_bf16 v[72:75], v[120:123], v[80:83], v[72:75]
  v_mfma_f32_16x16x32_bf16 v[72:75], v[136:139], v[84:87], v[72:75]
  v_mfma_f32_16x16x32_bf16 v[76:79], v[124:127], v[80:83], v[76:79]
  v_mfma_f32_16x16x32_bf16 v[76:79], v[140:143], v[84:87], v[76:79]
  ds_write_b128 v8, v[48:51] offset:8704
  ds_write_b128 v8, v[52:55] offset:8768
  s_waitcnt vmcnt(0)
  v_mfma_f32_16x16x32_bf16 v[64:67], v[144:147], v[88:91], v[64:67]
  v_mfma_f32_16x16x32_bf16 v[64:67], v[160:163], v[92:95], v[64:67]
  v_mfma_f32_16x16x32_bf16 v[68:71], v[148:151], v[88:91], v[68:71]
  v_mfma_f32_16x16x32_bf16 v[68:71], v[164:167], v[92:95], v[68:71]
  v_mfma_f32_16x16x32_bf16 v[72:75], v[152:155], v[88:91], v[72:75]
  v_mfma_f32_16x16x32_bf16 v[72:75], v[168:171], v[92:95], v[72:75]
  v_mfma_f32_16x16x32_bf16 v[76:79], v[156:159], v[88:91], v[76:79]
  v_mfma_f32_16x16x32_bf16 v[76:79], v[172:175], v[92:95], v[76:79]
  ds_write_b128 v8, v[56:59] offset:8832
  ds_write_b128 v8, v[60:63] offset:8896
  s_nop 7
  ds_write_b128 v8, v[64:67] offset:13056
  ds_write_b128 v8, v[68:71] offset:13120
  ds_write_b128 v8, v[72:75] offset:13184
  ds_write_b128 v8, v[76:79] offset:13248
  v_lshrrev_b32 v1, 4, v0
  s_lshl_b32 s53, s44, 2
  v_add_u32 v1, s53, v1
  v_mul_u32_u24 v1, 272, v1
  v_and_b32 v2, 15, v0
  v_lshlrev_b32 v2, 4, v2
  v_add_u32 v1, v1, v2
  v_add_u32 v2, 69632, v1
HOP97:
  s_cbranch_execz L_hopret
  s_waitcnt lgkmcnt(0)
  s_barrier
  ds_read_b128 v[16:19], v1 offset:0
  ds_read_b128 v[20:23], v1 offset:17408
  ds_read_b128 v[24:27], v1 offset:34816
  ds_read_b128 v[28:31], v1 offset:52224
  ds_read_b128 v[32:35], v2 offset:0
  ds_read_b128 v[36:39], v2 offset:17408
  ds_read_b128 v[40:43], v2 offset:34816
  ds_read_b128 v[44:47], v2 offset:52224
  ds_read_b128 v[48:51], v1 offset:8704
  ds_read_b128 v[52:55], v1 offset:26112
  ds_read_b128 v[56:59], v1 offset:43520
  ds_read_b128 v[60:63], v1 offset:60928
  ds_read_b128 v[64:67], v2 offset:8704
  ds_read_b128 v[68:71], v2 offset:26112
  ds_read_b128 v[72:75], v2 offset:43520
  ds_read_b128 v[76:79], v2 offset:60928
  s_waitcnt lgkmcnt(8)
  v_pk_add_f32 v[16:17], v[16:17], v[32:33]
  v_pk_add_f32 v[18:19], v[18:19], v[34:35]
  v_pk_add_f32 v[20:21], v[20:21], v[36:37]
  v_pk_add_f32 v[22:23], v[22:23], v[38:39]
  v_pk_add_f32 v[24:25], v[24:25], v[40:41]
  v_pk_add_f32 v[26:27], v[26:27], v[42:43]
  v_pk_add_f32 v[28:29], v[28:29], v[44:45]
  v_pk_add_f32 v[30:31], v[30:31], v[46:47]
  v_pk_add_f32 v[16:17], v[16:17], v[24:25]
  v_pk_add_f32 v[18:19], v[18:19], v[26:27]
  v_pk_add_f32 v[20:21], v[20:21], v[28:29]
  v_pk_add_f32 v[22:23], v[22:23], v[30:31]
  v_pk_add_f32 v[16:17], v[16:17], v[20:21]
HOP98:
  s_cbranch_execz L_hopret
  v_pk_add_f32 v[18:19], v[18:19], v[22:23]
  v_lshlrev_b32 v4, 16, v10
  v_and_b32 v5, 0xffff0000, v10
  v_lshlrev_b32 v6, 16, v11
  v_and_b32 v7, 0xffff0000, v11
  v_pk_add_f32 v[16:17], v[16:17], v[4:5]
  v_pk_add_f32 v[18:19], v[18:19], v[6:7]
  v_cvt_pk_bf16_f32 v20, v16, v17
  v_cvt_pk_bf16_f32 v21, v18, v19
  buffer_store_dwordx2 v[20:21], v14, s[28:31], 0 offen
  s_waitcnt lgkmcnt(0)
  v_pk_add_f32 v[48:49], v[48:49], v[64:65]
  v_pk_add_f32 v[50:51], v[50:51], v[66:67]
  v_pk_add_f32 v[52:53], v[52:53], v[68:69]
  v_pk_add_f32 v[54:55], v[54:55], v[70:71]
  v_pk_add_f32 v[56:57], v[56:57], v[72:73]
  v_pk_add_f32 v[58:59], v[58:59], v[74:75]
  v_pk_add_f32 v[60:61], v[60:61], v[76:77]
  v_pk_add_f32 v[62:63], v[62:63], v[78:79]
  v_pk_add_f32 v[48:49], v[48:49], v[56:57]
  v_pk_add_f32 v[50:51], v[50:51], v[58:59]
  v_pk_add_f32 v[52:53], v[52:53], v[60:61]
  v_pk_add_f32 v[54:55], v[54:55], v[62:63]
  v_pk_add_f32 v[48:49], v[48:49], v[52:53]
  v_pk_add_f32 v[50:51], v[50:51], v[54:55]
  v_lshlrev_b32 v4, 16, v12
  v_and_b32 v5, 0xffff0000, v12
  v_lshlrev_b32 v6, 16, v13
  v_and_b32 v7, 0xffff0000, v13
  v_pk_add_f32 v[48:49], v[48:49], v[4:5]
  v_pk_add_f32 v[50:51], v[50:51], v[6:7]
  v_cvt_pk_bf16_f32 v52, v48, v49
  v_cvt_pk_bf16_f32 v53, v50, v51
HOP99:
  s_cbranch_execz L_hopret
  buffer_store_dwordx2 v[52:53], v14, s[28:31], s83 offen
L_fin:
  s_cmp_eq_u32 s44, 6
  s_cbranch_scc0 L_end
  s_cmp_eq_u32 s66, 31
  s_cbranch_scc0 L_end
  s_cmp_eq_u32 s49, 0
  s_cbranch_scc0 L_end
  v_lshlrev_b32 v1, 7, v0
  v_add_u32 v1, 11993088, v1
  s_mov_b32 s53, 0
L_pe:
  s_mov_b32 s54, 8192
  s_mov_b32 s55, 16384
  s_mov_b32 s56, 24576
  buffer_load_dword v4, v1, s[40:43], 0 offen sc1
  buffer_load_dword v5, v1, s[40:43], s54 offen sc1
  buffer_load_dword v6, v1, s[40:43], s55 offen sc1
  buffer_load_dword v7, v1, s[40:43], s56 offen sc1
  s_waitcnt vmcnt(0)
  v_xor_b32 v4, s67, v4
  v_xor_b32 v5, s67, v5
  v_xor_b32 v6, s67, v6
  v_xor_b32 v7, s67, v7
  v_or_b32 v4, v4, v5
  v_or3_b32 v4, v4, v6, v7
  v_cmp_eq_u32 vcc, 0, v4
  s_add_u32 s53, s53, 1
  s_cmp_eq_u64 vcc, exec
  s_cbranch_scc1 L_ped
  s_sleep 8
  s_cmp_lt_u32 s53, 0x8000
  s_cbranch_scc1 L_pe
L_ped:
  v_mov_b32 v1, 11931648
  v_mov_b32 v2, s67
  v_cmp_eq_u32 vcc, 0, v0
  s_nop 0
  s_and_saveexec_b64 s[74:75], vcc
  buffer_store_dword v2, v1, s[40:43], 0 offen sc1
L_end:
  s_endpgm
.section .rodata,"a"
.p2align 6
.amdhsa_kernel parallel_sum__sliding_local_dilated__glu_gated_bilinear__prompt_kernel
  .amdhsa_next_free_vgpr 256
  .amdhsa_next_free_sgpr 102
  .amdhsa_accum_offset 256
  .amdhsa_group_segment_fixed_size 0
  .amdhsa_kernarg_size 80
  .amdhsa_user_sgpr_count 2
  .amdhsa_user_sgpr_kernarg_segment_ptr 1
  .amdhsa_system_sgpr_workgroup_id_x 1
.end_amdhsa_kernel
```
